```python
import torch

def _softmax(x, axis=-1):
    return torch.softmax(x, dim=axis)
def _gelu(x):
    return torch.nn.functional.gelu(x, approximate="tanh")
def _silu(x):
    return torch.nn.functional.silu(x)
def _sigmoid(x):
    return torch.sigmoid(x)
def _layernorm(x, axis=-1, eps=1e-5):
    m = x.mean(dim=axis, keepdim=True)
    v = x.var(dim=axis, keepdim=True, unbiased=False)
    return (x - m) / torch.sqrt(v + eps)
def _scatter_add(tgt, idx, src, axis=0):
    return tgt.clone().index_add_(axis, idx, src)
def _segment_sum(src, seg, n):
    out = torch.zeros((n,) + src.shape[1:], dtype=src.dtype)
    return out.index_add_(0, seg, src)
def _pad(x, pw):
    flat = tuple(v for pair in reversed(pw) for v in pair)
    return torch.nn.functional.pad(x, flat)

kernel_name = 'standalone__gqa_softmax__near_ridge'

def setup_inputs():

    _w = (lambda a: (lambda t: t.to(torch.bfloat16) if t.is_floating_point() else t)(torch.as_tensor(a)))
    B, Hq, Hkv, Sq, Sk, D = 8, 32, 16, 160, 2048, 128
    return {
        "q": _w((lambda *s: torch.randn(*s, dtype=torch.bfloat16) * 0.8)(B, Hq, Sq, D)),
        "k": _w((lambda *s: torch.randn(*s, dtype=torch.bfloat16) * 0.8)(B, Hkv, Sk, D)),
        "v": _w((lambda *s: torch.randn(*s, dtype=torch.bfloat16) * 0.05)(B, Hkv, Sk, D)),
    }

def reference(q, k, v):
    B, Hq, Sq, D = q.shape
    Hkv = k.shape[1]
    rep = Hq // Hkv
    k = (lambda x, n, axis: torch.repeat_interleave(x, n, dim=axis))(k, rep, axis=1)
    v = (lambda x, n, axis: torch.repeat_interleave(x, n, dim=axis))(v, rep, axis=1)
    scale = D ** -0.5
    scores = torch.einsum("bhqd,bhkd->bhqk", q, k) * scale
    p = _softmax(scores, axis=-1)
    return torch.einsum("bhqk,bhkd->bhqd", p, v)
```

```asm
; @launch grid=(256,1,1) block=(256,1,1) lds=163840
.amdgcn_target "amdgcn-amd-amdhsa--gfx950"
.text
.globl standalone__gqa_softmax__near_ridge_kernel
.p2align 8
.type standalone__gqa_softmax__near_ridge_kernel,@function
standalone__gqa_softmax__near_ridge_kernel:
    s_cmp_ge_u32 s2, 256
    s_cbranch_scc1 L_end
    s_load_dwordx8 s[4:11], s[0:1], 0
    v_lshrrev_b32 v250, 6, v0
    v_and_b32 v2, 15, v0
    v_bfe_u32 v3, v0, 4, 2
    v_readfirstlane_b32 s36, v250
    s_lshr_b32 s48, s2, 4
    s_lshl_b32 s48, s48, 3
    s_and_b32 s49, s2, 7
    s_or_b32 s48, s48, s49
    s_bfe_u32 s49, s2, 0x10003
    s_lshl_b32 s50, s48, 1
    s_add_u32 s50, s50, s49
    s_mul_i32 s50, s50, 40960
    s_lshl_b32 s51, s48, 19
    s_and_b32 s52, s36, 1
    s_lshr_b32 s53, s36, 1
    s_lshl_b32 s49, s36, 3
    v_add_u32 v250, s49, v3
    v_lshlrev_b32 v251, 8, v250
    s_lshl_b32 s48, s53, 14
    v_add_u32 v252, 0, v250
    v_and_b32 v253, 15, v252
    v_xor_b32 v253, v253, v2
    v_lshl_add_u32 v232, v253, 4, v251
    v_add_u32 v10, s48, v232
    v_add_u32 v252, 4, v250
    v_and_b32 v253, 15, v252
    v_xor_b32 v253, v253, v2
    v_lshl_add_u32 v233, v253, 4, v251
    v_add_u32 v11, s48, v233
    s_lshl_b32 s37, s36, 11
    s_mul_i32 s48, s53, 20480
    s_lshl_b32 s49, s52, 11
    s_add_u32 s58, s48, s49
    s_add_u32 s58, s58, 131072
    s_add_u32 s49, s49, 12288
    s_cmp_eq_u32 s53, 0
    s_cselect_b32 s59, s58, s49
    s_mov_b32 s44, 4096
    s_mov_b32 s45, 8192
    s_mov_b32 s46, 12288
    s_mov_b32 s47, 16384
    s_waitcnt lgkmcnt(0)
    s_add_u32 s28, s4, s50
    s_addc_u32 s29, s5, 0
    s_and_b32 s29, s29, 0xffff
    s_mov_b32 s30, 40960
    s_mov_b32 s31, 0x20000
    s_add_u32 s12, s6, s51
    s_addc_u32 s13, s7, 0
    s_and_b32 s13, s13, 0xffff
    s_mov_b32 s14, 262144
    s_mov_b32 s15, 0x20000
    s_add_u32 s16, s6, s51
    s_addc_u32 s17, s7, 0
    s_add_u32 s16, s16, 262144
    s_addc_u32 s17, s17, 0
    s_and_b32 s17, s17, 0xffff
    s_mov_b32 s18, 262144
    s_mov_b32 s19, 0x20000
    s_add_u32 m0, s58, 0
    s_nop 0
    buffer_load_dwordx4 v10, s[28:31], 0 offen nt lds
    buffer_load_dwordx4 v11, s[28:31], 0 offen offset:1024 nt lds
    s_add_u32 m0, s37, 0
    s_nop 0
    buffer_load_dwordx4 v232, s[12:15], 0 offen sc1 nt lds
    buffer_load_dwordx4 v233, s[12:15], 0 offen offset:1024 sc1 nt lds
    s_add_u32 m0, s37, 65536
    s_nop 0
    buffer_load_dwordx4 v232, s[16:19], 0 offen sc1 nt lds
    buffer_load_dwordx4 v233, s[16:19], 0 offen offset:1024 sc1 nt lds
    v_add_u32 v232, s45, v232
    v_add_u32 v233, s45, v233
    s_add_u32 s20, s8, s51
    s_addc_u32 s21, s9, 0
    s_and_b32 s21, s21, 0xffff
    s_mov_b32 s22, 262144
    s_mov_b32 s23, 0x20000
    s_add_u32 s24, s8, s51
    s_addc_u32 s25, s9, 0
    s_add_u32 s24, s24, 262144
    s_addc_u32 s25, s25, 0
    s_and_b32 s25, s25, 0xffff
    s_mov_b32 s26, 262144
    s_mov_b32 s27, 0x20000
    s_add_u32 s32, s10, s50
    s_addc_u32 s33, s11, 0
    s_and_b32 s33, s33, 0xffff
    s_mov_b32 s34, 40960
    s_mov_b32 s35, 0x20000
    s_add_u32 s41, s37, 32768
    v_add_u32 v252, 0, v250
    v_and_b32 v253, 7, v252
    v_lshlrev_b32 v253, 1, v253
    v_xor_b32 v253, v253, v2
    v_lshl_add_u32 v234, v253, 4, v251
    v_add_u32 v252, 4, v250
    v_and_b32 v253, 7, v252
    v_lshlrev_b32 v253, 1, v253
    v_xor_b32 v253, v253, v2
    v_lshl_add_u32 v235, v253, 4, v251
    s_add_u32 m0, s58, 4096
    s_nop 0
    buffer_load_dwordx4 v10, s[28:31], s44 offen nt lds
    buffer_load_dwordx4 v11, s[28:31], s44 offen offset:1024 nt lds
    s_add_u32 m0, s58, 8192
    s_nop 0
    buffer_load_dwordx4 v10, s[28:31], s45 offen nt lds
    buffer_load_dwordx4 v11, s[28:31], s45 offen offset:1024 nt lds
    v_and_b32 v1, 63, v0
    s_mov_b32 s42, 1040356334
    s_mov_b32 s43, 1040356334
    s_mov_b32 s56, 0xffff0000
    s_mov_b32 s54, 1400897536
    s_lshl_b32 s48, s53, 16
    v_lshrrev_b32 v250, 2, v2
    v_and_b32 v251, 3, v2
    v_xor_b32 v252, v251, v3
    v_lshlrev_b32 v252, 4, v252
    v_lshl_add_u32 v252, v2, 8, v252
    s_mul_i32 s49, s52, 20480
    s_add_u32 s49, s49, 131072
    s_cmp_eq_u32 s52, 0
    s_cselect_b32 s50, s49, 12288
    v_xor_b32 v253, 0, v250
    v_lshl_add_u32 v253, v253, 6, v252
    v_add_u32 v220, s48, v253
    v_add_u32 v176, s49, v253
    v_add_u32 v180, s50, v253
    v_xor_b32 v253, 1, v250
    v_lshl_add_u32 v253, v253, 6, v252
    v_add_u32 v221, s48, v253
    v_add_u32 v177, s49, v253
    v_add_u32 v181, s50, v253
    v_xor_b32 v253, 2, v250
    v_lshl_add_u32 v253, v253, 6, v252
    v_add_u32 v222, s48, v253
    v_add_u32 v178, s49, v253
    v_add_u32 v182, s50, v253
    v_xor_b32 v253, 3, v250
    v_lshl_add_u32 v253, v253, 6, v252
    v_add_u32 v223, s48, v253
    v_add_u32 v179, s49, v253
    v_add_u32 v183, s50, v253
    v_lshl_add_u32 v253, v3, 2, v250
    v_lshlrev_b32 v254, 8, v253
    v_lshl_add_u32 v254, v251, 3, v254
    s_add_u32 s49, s48, 32768
    v_add_u32 v254, s49, v254
    v_and_b32 v253, 7, v253
    s_lshl_b32 s49, s53, 2
    v_xor_b32 v253, s49, v253
    v_xor_b32 v255, 0, v253
    v_lshl_add_u32 v224, v255, 5, v254
    v_xor_b32 v255, 1, v253
    v_lshl_add_u32 v225, v255, 5, v254
    v_xor_b32 v255, 2, v253
    v_lshl_add_u32 v226, v255, 5, v254
    v_xor_b32 v255, 3, v253
    v_lshl_add_u32 v227, v255, 5, v254
    v_xor_b32 v255, 4, v253
    v_lshl_add_u32 v228, v255, 5, v254
    v_xor_b32 v255, 5, v253
    v_lshl_add_u32 v229, v255, 5, v254
    v_xor_b32 v255, 6, v253
    v_lshl_add_u32 v230, v255, 5, v254
    v_xor_b32 v255, 7, v253
    v_lshl_add_u32 v231, v255, 5, v254
    v_mov_b32 v250, 0x3f803f80
    v_cmp_eq_u32 vcc, 0, v251
    s_nop 1
    v_cndmask_b32 v236, 0, v250, vcc
    v_mov_b32 v237, v236
    v_mov_b32 v238, v236
    v_mov_b32 v239, v236
    s_lshl_b32 s49, s52, 15
    s_add_u32 s50, s48, s49
    v_lshlrev_b32 v250, 4, v1
    v_add_u32 v5, s50, v250
    v_xor_b32 v6, 0x10000, v5
    s_lshl_b32 s49, s52, 10
    s_add_u32 s50, s48, s49
    s_add_u32 s50, s50, 20480
    v_lshlrev_b32 v250, 3, v2
    v_add_u32 v7, s50, v250
    v_xor_b32 v8, 0x10000, v7
    s_mul_i32 s49, s52, 20480
    s_lshl_b32 s50, s53, 7
    s_add_u32 s49, s49, s50
    v_lshrrev_b32 v250, 3, v1
    v_and_b32 v251, 7, v1
    v_lshlrev_b32 v252, 4, v251
    v_lshl_add_u32 v252, v250, 8, v252
    v_add_u32 v4, s49, v252
    s_lshl_b32 s49, s36, 13
    s_add_u32 s49, s49, 131072
    v_xor_b32 v251, v251, v250
    v_lshlrev_b32 v251, 4, v251
    v_lshl_add_u32 v251, v250, 7, v251
    v_add_u32 v9, s49, v251
    v_and_b32 v250, 7, v2
    v_lshrrev_b32 v251, 1, v3
    v_xor_b32 v250, v250, v251
    v_and_b32 v251, 1, v3
    v_lshlrev_b32 v251, 3, v251
    v_lshl_add_u32 v251, v2, 7, v251
    v_add_u32 v251, s49, v251
    v_xor_b32 v252, 0, v250
    v_lshl_add_u32 v12, v252, 4, v251
    v_xor_b32 v252, 2, v250
    v_lshl_add_u32 v13, v252, 4, v251
    v_xor_b32 v252, 4, v250
    v_lshl_add_u32 v14, v252, 4, v251
    v_xor_b32 v252, 6, v250
    v_lshl_add_u32 v15, v252, 4, v251
    s_mov_b32 s55, 0
    v_mov_b32 v240, 0xff800000
    v_mov_b32 v241, 0xff800000
    v_mov_b32 v242, 0xff800000
    v_mov_b32 v243, 0xff800000
    v_mov_b32 v244, 0xff800000
    s_waitcnt vmcnt(4)
    s_barrier
    ds_read_b128 v[16:19], v176 offset:0
    ds_read_b128 v[20:23], v177 offset:0
    ds_read_b128 v[24:27], v178 offset:0
    ds_read_b128 v[28:31], v179 offset:0
    ds_read_b128 a[100:103], v220 offset:0
    ds_read_b128 a[104:107], v221 offset:0
    ds_read_b128 a[108:111], v222 offset:0
    ds_read_b128 a[112:115], v223 offset:0
    ds_read_b128 a[116:119], v220 offset:4096
    ds_read_b128 a[120:123], v221 offset:4096
    ds_read_b128 a[124:127], v222 offset:4096
    ds_read_b128 a[128:131], v223 offset:4096
    s_add_u32 m0, s59, 12288
    s_nop 0
    buffer_load_dwordx4 v10, s[28:31], s46 offen nt lds
    buffer_load_dwordx4 v11, s[28:31], s46 offen offset:1024 nt lds
    s_add_u32 m0, s59, 16384
    s_nop 0
    buffer_load_dwordx4 v10, s[28:31], s47 offen nt lds
    buffer_load_dwordx4 v11, s[28:31], s47 offen offset:1024 nt lds
    s_waitcnt lgkmcnt(8)
    v_lshlrev_b32 v250, 16, v16
    v_and_b32 v251, s56, v16
    v_lshlrev_b32 v252, 16, v17
    v_and_b32 v253, s56, v17
    v_pk_mul_f32 v[250:251], v[250:251], s[42:43]
    v_pk_mul_f32 v[252:253], v[252:253], s[42:43]
    v_cvt_pk_bf16_f32 v16, v250, v251
    v_cvt_pk_bf16_f32 v17, v252, v253
    v_lshlrev_b32 v250, 16, v18
    v_and_b32 v251, s56, v18
    v_lshlrev_b32 v252, 16, v19
    v_and_b32 v253, s56, v19
    v_pk_mul_f32 v[250:251], v[250:251], s[42:43]
    v_pk_mul_f32 v[252:253], v[252:253], s[42:43]
    v_cvt_pk_bf16_f32 v18, v250, v251
    v_cvt_pk_bf16_f32 v19, v252, v253
    v_lshlrev_b32 v250, 16, v20
    v_and_b32 v251, s56, v20
    v_lshlrev_b32 v252, 16, v21
    v_and_b32 v253, s56, v21
    v_pk_mul_f32 v[250:251], v[250:251], s[42:43]
    v_pk_mul_f32 v[252:253], v[252:253], s[42:43]
    v_cvt_pk_bf16_f32 v20, v250, v251
    v_cvt_pk_bf16_f32 v21, v252, v253
    v_lshlrev_b32 v250, 16, v22
    v_and_b32 v251, s56, v22
    v_lshlrev_b32 v252, 16, v23
    v_and_b32 v253, s56, v23
    v_pk_mul_f32 v[250:251], v[250:251], s[42:43]
    v_pk_mul_f32 v[252:253], v[252:253], s[42:43]
    v_cvt_pk_bf16_f32 v22, v250, v251
    v_cvt_pk_bf16_f32 v23, v252, v253
    v_lshlrev_b32 v250, 16, v24
    v_and_b32 v251, s56, v24
    v_lshlrev_b32 v252, 16, v25
    v_and_b32 v253, s56, v25
    v_pk_mul_f32 v[250:251], v[250:251], s[42:43]
    v_pk_mul_f32 v[252:253], v[252:253], s[42:43]
    v_cvt_pk_bf16_f32 v24, v250, v251
    v_cvt_pk_bf16_f32 v25, v252, v253
    v_lshlrev_b32 v250, 16, v26
    v_and_b32 v251, s56, v26
    v_lshlrev_b32 v252, 16, v27
    v_and_b32 v253, s56, v27
    v_pk_mul_f32 v[250:251], v[250:251], s[42:43]
    v_pk_mul_f32 v[252:253], v[252:253], s[42:43]
    v_cvt_pk_bf16_f32 v26, v250, v251
    v_cvt_pk_bf16_f32 v27, v252, v253
    v_lshlrev_b32 v250, 16, v28
    v_and_b32 v251, s56, v28
    v_lshlrev_b32 v252, 16, v29
    v_and_b32 v253, s56, v29
    v_pk_mul_f32 v[250:251], v[250:251], s[42:43]
    v_pk_mul_f32 v[252:253], v[252:253], s[42:43]
    v_cvt_pk_bf16_f32 v28, v250, v251
    v_cvt_pk_bf16_f32 v29, v252, v253
    v_lshlrev_b32 v250, 16, v30
    v_and_b32 v251, s56, v30
    v_lshlrev_b32 v252, 16, v31
    v_and_b32 v253, s56, v31
    v_pk_mul_f32 v[250:251], v[250:251], s[42:43]
    v_pk_mul_f32 v[252:253], v[252:253], s[42:43]
    v_cvt_pk_bf16_f32 v30, v250, v251
    v_cvt_pk_bf16_f32 v31, v252, v253
    s_waitcnt vmcnt(6)
    s_waitcnt lgkmcnt(0)
    s_barrier
    ds_read_b128 v[32:35], v176 offset:4096
    ds_read_b128 v[36:39], v177 offset:4096
    ds_read_b128 v[40:43], v178 offset:4096
    ds_read_b128 v[44:47], v179 offset:4096
    v_mfma_f32_16x16x32_bf16 v[96:99], a[100:103], v[16:19], 0
    v_mfma_f32_16x16x32_bf16 v[96:99], a[104:107], v[20:23], v[96:99]
    v_mfma_f32_16x16x32_bf16 v[96:99], a[108:111], v[24:27], v[96:99]
    v_mfma_f32_16x16x32_bf16 v[96:99], a[112:115], v[28:31], v[96:99]
    v_mfma_f32_16x16x32_bf16 v[100:103], a[116:119], v[16:19], 0
    v_mfma_f32_16x16x32_bf16 v[100:103], a[120:123], v[20:23], v[100:103]
    v_mfma_f32_16x16x32_bf16 v[100:103], a[124:127], v[24:27], v[100:103]
    v_mfma_f32_16x16x32_bf16 v[100:103], a[128:131], v[28:31], v[100:103]
    s_waitcnt lgkmcnt(0)
    v_lshlrev_b32 v250, 16, v32
    v_and_b32 v251, s56, v32
    v_lshlrev_b32 v252, 16, v33
    v_and_b32 v253, s56, v33
    v_pk_mul_f32 v[250:251], v[250:251], s[42:43]
    v_pk_mul_f32 v[252:253], v[252:253], s[42:43]
    v_cvt_pk_bf16_f32 v32, v250, v251
    v_cvt_pk_bf16_f32 v33, v252, v253
    v_lshlrev_b32 v250, 16, v34
    v_and_b32 v251, s56, v34
    v_lshlrev_b32 v252, 16, v35
    v_and_b32 v253, s56, v35
    v_pk_mul_f32 v[250:251], v[250:251], s[42:43]
    v_pk_mul_f32 v[252:253], v[252:253], s[42:43]
    v_cvt_pk_bf16_f32 v34, v250, v251
    v_cvt_pk_bf16_f32 v35, v252, v253
    v_lshlrev_b32 v250, 16, v36
    v_and_b32 v251, s56, v36
    v_lshlrev_b32 v252, 16, v37
    v_and_b32 v253, s56, v37
    v_pk_mul_f32 v[250:251], v[250:251], s[42:43]
    v_pk_mul_f32 v[252:253], v[252:253], s[42:43]
    v_cvt_pk_bf16_f32 v36, v250, v251
    v_cvt_pk_bf16_f32 v37, v252, v253
    v_lshlrev_b32 v250, 16, v38
    v_and_b32 v251, s56, v38
    v_lshlrev_b32 v252, 16, v39
    v_and_b32 v253, s56, v39
    v_pk_mul_f32 v[250:251], v[250:251], s[42:43]
    v_pk_mul_f32 v[252:253], v[252:253], s[42:43]
    v_cvt_pk_bf16_f32 v38, v250, v251
    v_cvt_pk_bf16_f32 v39, v252, v253
    v_lshlrev_b32 v250, 16, v40
    v_and_b32 v251, s56, v40
    v_lshlrev_b32 v252, 16, v41
    v_and_b32 v253, s56, v41
    v_pk_mul_f32 v[250:251], v[250:251], s[42:43]
    v_pk_mul_f32 v[252:253], v[252:253], s[42:43]
    v_cvt_pk_bf16_f32 v40, v250, v251
    v_cvt_pk_bf16_f32 v41, v252, v253
    v_lshlrev_b32 v250, 16, v42
    v_and_b32 v251, s56, v42
    v_lshlrev_b32 v252, 16, v43
    v_and_b32 v253, s56, v43
    v_pk_mul_f32 v[250:251], v[250:251], s[42:43]
    v_pk_mul_f32 v[252:253], v[252:253], s[42:43]
    v_cvt_pk_bf16_f32 v42, v250, v251
    v_cvt_pk_bf16_f32 v43, v252, v253
    v_lshlrev_b32 v250, 16, v44
    v_and_b32 v251, s56, v44
    v_lshlrev_b32 v252, 16, v45
    v_and_b32 v253, s56, v45
    v_pk_mul_f32 v[250:251], v[250:251], s[42:43]
    v_pk_mul_f32 v[252:253], v[252:253], s[42:43]
    v_cvt_pk_bf16_f32 v44, v250, v251
    v_cvt_pk_bf16_f32 v45, v252, v253
    v_lshlrev_b32 v250, 16, v46
    v_and_b32 v251, s56, v46
    v_lshlrev_b32 v252, 16, v47
    v_and_b32 v253, s56, v47
    v_pk_mul_f32 v[250:251], v[250:251], s[42:43]
    v_pk_mul_f32 v[252:253], v[252:253], s[42:43]
    v_cvt_pk_bf16_f32 v46, v250, v251
    v_cvt_pk_bf16_f32 v47, v252, v253
    v_max3_f32 v254, v96, v97, v98
    v_max3_f32 v254, v254, v99, v100
    v_max3_f32 v254, v254, v101, v102
    v_max3_f32 v254, v254, v103, v240
    v_mov_b32 v255, v254
    s_nop 1
    v_permlane32_swap_b32 v254, v255
    v_max_f32 v254, v254, v255
    v_mov_b32 v255, v254
    s_nop 1
    v_permlane16_swap_b32 v254, v255
    v_max_f32 v254, v254, v255
    v_sub_f32 v96, v96, v254
    v_sub_f32 v97, v97, v254
    v_sub_f32 v98, v98, v254
    v_sub_f32 v99, v99, v254
    v_sub_f32 v100, v100, v254
    v_sub_f32 v101, v101, v254
    v_sub_f32 v102, v102, v254
    v_sub_f32 v103, v103, v254
    v_sub_f32 v200, 0, v254
    v_sub_f32 v201, 0, v254
    v_sub_f32 v202, 0, v254
    v_sub_f32 v203, 0, v254
    s_add_u32 m0, s41, 0
    s_nop 0
    buffer_load_dwordx4 v234, s[20:23], 0 offen sc1 nt lds
    buffer_load_dwordx4 v235, s[20:23], 0 offen offset:1024 sc1 nt lds
    s_add_u32 m0, s41, 65536
    s_nop 0
    buffer_load_dwordx4 v234, s[24:27], 0 offen sc1 nt lds
    buffer_load_dwordx4 v235, s[24:27], 0 offen offset:1024 sc1 nt lds
    v_add_u32 v234, s45, v234
    v_add_u32 v235, s45, v235
    s_waitcnt vmcnt(8)
    s_barrier
    ds_read_b128 v[48:51], v176 offset:8192
    ds_read_b128 v[52:55], v177 offset:8192
    ds_read_b128 v[56:59], v178 offset:8192
    ds_read_b128 v[60:63], v179 offset:8192
    v_mfma_f32_16x16x32_bf16 v[112:115], a[100:103], v[32:35], 0
    v_exp_f32 v96, v96
    v_mfma_f32_16x16x32_bf16 v[112:115], a[104:107], v[36:39], v[112:115]
    v_exp_f32 v97, v97
    v_mfma_f32_16x16x32_bf16 v[112:115], a[108:111], v[40:43], v[112:115]
    v_exp_f32 v98, v98
    v_mfma_f32_16x16x32_bf16 v[112:115], a[112:115], v[44:47], v[112:115]
    v_exp_f32 v99, v99
    v_mfma_f32_16x16x32_bf16 v[116:119], a[116:119], v[32:35], 0
    v_exp_f32 v100, v100
    v_mfma_f32_16x16x32_bf16 v[116:119], a[120:123], v[36:39], v[116:119]
    v_exp_f32 v101, v101
    v_mfma_f32_16x16x32_bf16 v[116:119], a[124:127], v[40:43], v[116:119]
    v_exp_f32 v102, v102
    v_mfma_f32_16x16x32_bf16 v[116:119], a[128:131], v[44:47], v[116:119]
    v_exp_f32 v103, v103
    v_cvt_pk_bf16_f32 v192, v96, v97
    v_cvt_pk_bf16_f32 v193, v98, v99
    v_cvt_pk_bf16_f32 v194, v100, v101
    v_cvt_pk_bf16_f32 v195, v102, v103
    s_waitcnt lgkmcnt(0)
    v_lshlrev_b32 v250, 16, v48
    v_and_b32 v251, s56, v48
    v_lshlrev_b32 v252, 16, v49
    v_and_b32 v253, s56, v49
    v_pk_mul_f32 v[250:251], v[250:251], s[42:43]
    v_pk_mul_f32 v[252:253], v[252:253], s[42:43]
    v_cvt_pk_bf16_f32 v48, v250, v251
    v_cvt_pk_bf16_f32 v49, v252, v253
    v_lshlrev_b32 v250, 16, v50
    v_and_b32 v251, s56, v50
    v_lshlrev_b32 v252, 16, v51
    v_and_b32 v253, s56, v51
    v_pk_mul_f32 v[250:251], v[250:251], s[42:43]
    v_pk_mul_f32 v[252:253], v[252:253], s[42:43]
    v_cvt_pk_bf16_f32 v50, v250, v251
    v_cvt_pk_bf16_f32 v51, v252, v253
    v_lshlrev_b32 v250, 16, v52
    v_and_b32 v251, s56, v52
    v_lshlrev_b32 v252, 16, v53
    v_and_b32 v253, s56, v53
    v_pk_mul_f32 v[250:251], v[250:251], s[42:43]
    v_pk_mul_f32 v[252:253], v[252:253], s[42:43]
    v_cvt_pk_bf16_f32 v52, v250, v251
    v_cvt_pk_bf16_f32 v53, v252, v253
    v_lshlrev_b32 v250, 16, v54
    v_and_b32 v251, s56, v54
    v_lshlrev_b32 v252, 16, v55
    v_and_b32 v253, s56, v55
    v_pk_mul_f32 v[250:251], v[250:251], s[42:43]
    v_pk_mul_f32 v[252:253], v[252:253], s[42:43]
    v_cvt_pk_bf16_f32 v54, v250, v251
    v_cvt_pk_bf16_f32 v55, v252, v253
    v_lshlrev_b32 v250, 16, v56
    v_and_b32 v251, s56, v56
    v_lshlrev_b32 v252, 16, v57
    v_and_b32 v253, s56, v57
    v_pk_mul_f32 v[250:251], v[250:251], s[42:43]
    v_pk_mul_f32 v[252:253], v[252:253], s[42:43]
    v_cvt_pk_bf16_f32 v56, v250, v251
    v_cvt_pk_bf16_f32 v57, v252, v253
    v_lshlrev_b32 v250, 16, v58
    v_and_b32 v251, s56, v58
    v_lshlrev_b32 v252, 16, v59
    v_and_b32 v253, s56, v59
    v_pk_mul_f32 v[250:251], v[250:251], s[42:43]
    v_pk_mul_f32 v[252:253], v[252:253], s[42:43]
    v_cvt_pk_bf16_f32 v58, v250, v251
    v_cvt_pk_bf16_f32 v59, v252, v253
    v_lshlrev_b32 v250, 16, v60
    v_and_b32 v251, s56, v60
    v_lshlrev_b32 v252, 16, v61
    v_and_b32 v253, s56, v61
    v_pk_mul_f32 v[250:251], v[250:251], s[42:43]
    v_pk_mul_f32 v[252:253], v[252:253], s[42:43]
    v_cvt_pk_bf16_f32 v60, v250, v251
    v_cvt_pk_bf16_f32 v61, v252, v253
    v_lshlrev_b32 v250, 16, v62
    v_and_b32 v251, s56, v62
    v_lshlrev_b32 v252, 16, v63
    v_and_b32 v253, s56, v63
    v_pk_mul_f32 v[250:251], v[250:251], s[42:43]
    v_pk_mul_f32 v[252:253], v[252:253], s[42:43]
    v_cvt_pk_bf16_f32 v62, v250, v251
    v_cvt_pk_bf16_f32 v63, v252, v253
    v_max3_f32 v254, v112, v113, v114
    v_max3_f32 v254, v254, v115, v116
    v_max3_f32 v254, v254, v117, v118
    v_max3_f32 v254, v254, v119, v241
    v_mov_b32 v255, v254
    s_nop 1
    v_permlane32_swap_b32 v254, v255
    v_max_f32 v254, v254, v255
    v_mov_b32 v255, v254
    s_nop 1
    v_permlane16_swap_b32 v254, v255
    v_max_f32 v254, v254, v255
    v_sub_f32 v112, v112, v254
    v_sub_f32 v113, v113, v254
    v_sub_f32 v114, v114, v254
    v_sub_f32 v115, v115, v254
    v_sub_f32 v116, v116, v254
    v_sub_f32 v117, v117, v254
    v_sub_f32 v118, v118, v254
    v_sub_f32 v119, v119, v254
    v_sub_f32 v204, 0, v254
    v_sub_f32 v205, 0, v254
    v_sub_f32 v206, 0, v254
    v_sub_f32 v207, 0, v254
    s_add_u32 m0, s37, 8192
    s_nop 0
    buffer_load_dwordx4 v232, s[12:15], 0 offen sc1 nt lds
    buffer_load_dwordx4 v233, s[12:15], 0 offen offset:1024 sc1 nt lds
    s_add_u32 m0, s37, 73728
    s_nop 0
    buffer_load_dwordx4 v232, s[16:19], 0 offen sc1 nt lds
    buffer_load_dwordx4 v233, s[16:19], 0 offen offset:1024 sc1 nt lds
    v_add_u32 v232, s45, v232
    v_add_u32 v233, s45, v233
    s_waitcnt vmcnt(10)
    s_barrier
    ds_read_b128 v[64:67], v180 offset:12288
    ds_read_b128 v[68:71], v181 offset:12288
    ds_read_b128 v[72:75], v182 offset:12288
    ds_read_b128 v[76:79], v183 offset:12288
    v_mfma_f32_16x16x32_bf16 v[128:131], a[100:103], v[48:51], 0
    v_exp_f32 v112, v112
    v_mfma_f32_16x16x32_bf16 v[128:131], a[104:107], v[52:55], v[128:131]
    v_exp_f32 v113, v113
    v_mfma_f32_16x16x32_bf16 v[128:131], a[108:111], v[56:59], v[128:131]
    v_exp_f32 v114, v114
    v_mfma_f32_16x16x32_bf16 v[128:131], a[112:115], v[60:63], v[128:131]
    v_exp_f32 v115, v115
    v_mfma_f32_16x16x32_bf16 v[132:135], a[116:119], v[48:51], 0
    v_exp_f32 v116, v116
    v_mfma_f32_16x16x32_bf16 v[132:135], a[120:123], v[52:55], v[132:135]
    v_exp_f32 v117, v117
    v_mfma_f32_16x16x32_bf16 v[132:135], a[124:127], v[56:59], v[132:135]
    v_exp_f32 v118, v118
    v_mfma_f32_16x16x32_bf16 v[132:135], a[128:131], v[60:63], v[132:135]
    v_exp_f32 v119, v119
    v_cvt_pk_bf16_f32 v184, v112, v113
    v_cvt_pk_bf16_f32 v185, v114, v115
    v_cvt_pk_bf16_f32 v186, v116, v117
    v_cvt_pk_bf16_f32 v187, v118, v119
    s_waitcnt lgkmcnt(0)
    v_lshlrev_b32 v250, 16, v64
    v_and_b32 v251, s56, v64
    v_lshlrev_b32 v252, 16, v65
    v_and_b32 v253, s56, v65
    v_pk_mul_f32 v[250:251], v[250:251], s[42:43]
    v_pk_mul_f32 v[252:253], v[252:253], s[42:43]
    v_cvt_pk_bf16_f32 v64, v250, v251
    v_cvt_pk_bf16_f32 v65, v252, v253
    v_lshlrev_b32 v250, 16, v66
    v_and_b32 v251, s56, v66
    v_lshlrev_b32 v252, 16, v67
    v_and_b32 v253, s56, v67
    v_pk_mul_f32 v[250:251], v[250:251], s[42:43]
    v_pk_mul_f32 v[252:253], v[252:253], s[42:43]
    v_cvt_pk_bf16_f32 v66, v250, v251
    v_cvt_pk_bf16_f32 v67, v252, v253
    v_lshlrev_b32 v250, 16, v68
    v_and_b32 v251, s56, v68
    v_lshlrev_b32 v252, 16, v69
    v_and_b32 v253, s56, v69
    v_pk_mul_f32 v[250:251], v[250:251], s[42:43]
    v_pk_mul_f32 v[252:253], v[252:253], s[42:43]
    v_cvt_pk_bf16_f32 v68, v250, v251
    v_cvt_pk_bf16_f32 v69, v252, v253
    v_lshlrev_b32 v250, 16, v70
    v_and_b32 v251, s56, v70
    v_lshlrev_b32 v252, 16, v71
    v_and_b32 v253, s56, v71
    v_pk_mul_f32 v[250:251], v[250:251], s[42:43]
    v_pk_mul_f32 v[252:253], v[252:253], s[42:43]
    v_cvt_pk_bf16_f32 v70, v250, v251
    v_cvt_pk_bf16_f32 v71, v252, v253
    v_lshlrev_b32 v250, 16, v72
    v_and_b32 v251, s56, v72
    v_lshlrev_b32 v252, 16, v73
    v_and_b32 v253, s56, v73
    v_pk_mul_f32 v[250:251], v[250:251], s[42:43]
    v_pk_mul_f32 v[252:253], v[252:253], s[42:43]
    v_cvt_pk_bf16_f32 v72, v250, v251
    v_cvt_pk_bf16_f32 v73, v252, v253
    v_lshlrev_b32 v250, 16, v74
    v_and_b32 v251, s56, v74
    v_lshlrev_b32 v252, 16, v75
    v_and_b32 v253, s56, v75
    v_pk_mul_f32 v[250:251], v[250:251], s[42:43]
    v_pk_mul_f32 v[252:253], v[252:253], s[42:43]
    v_cvt_pk_bf16_f32 v74, v250, v251
    v_cvt_pk_bf16_f32 v75, v252, v253
    v_lshlrev_b32 v250, 16, v76
    v_and_b32 v251, s56, v76
    v_lshlrev_b32 v252, 16, v77
    v_and_b32 v253, s56, v77
    v_pk_mul_f32 v[250:251], v[250:251], s[42:43]
    v_pk_mul_f32 v[252:253], v[252:253], s[42:43]
    v_cvt_pk_bf16_f32 v76, v250, v251
    v_cvt_pk_bf16_f32 v77, v252, v253
    v_lshlrev_b32 v250, 16, v78
    v_and_b32 v251, s56, v78
    v_lshlrev_b32 v252, 16, v79
    v_and_b32 v253, s56, v79
    v_pk_mul_f32 v[250:251], v[250:251], s[42:43]
    v_pk_mul_f32 v[252:253], v[252:253], s[42:43]
    v_cvt_pk_bf16_f32 v78, v250, v251
    v_cvt_pk_bf16_f32 v79, v252, v253
    v_max3_f32 v254, v128, v129, v130
    v_max3_f32 v254, v254, v131, v132
    v_max3_f32 v254, v254, v133, v134
    v_max3_f32 v254, v254, v135, v242
    v_mov_b32 v255, v254
    s_nop 1
    v_permlane32_swap_b32 v254, v255
    v_max_f32 v254, v254, v255
    v_mov_b32 v255, v254
    s_nop 1
    v_permlane16_swap_b32 v254, v255
    v_max_f32 v254, v254, v255
    v_sub_f32 v128, v128, v254
    v_sub_f32 v129, v129, v254
    v_sub_f32 v130, v130, v254
    v_sub_f32 v131, v131, v254
    v_sub_f32 v132, v132, v254
    v_sub_f32 v133, v133, v254
    v_sub_f32 v134, v134, v254
    v_sub_f32 v135, v135, v254
    v_sub_f32 v208, 0, v254
    v_sub_f32 v209, 0, v254
    v_sub_f32 v210, 0, v254
    v_sub_f32 v211, 0, v254
    s_add_u32 m0, s41, 8192
    s_nop 0
    buffer_load_dwordx4 v234, s[20:23], 0 offen sc1 nt lds
    buffer_load_dwordx4 v235, s[20:23], 0 offen offset:1024 sc1 nt lds
    s_add_u32 m0, s41, 73728
    s_nop 0
    buffer_load_dwordx4 v234, s[24:27], 0 offen sc1 nt lds
    buffer_load_dwordx4 v235, s[24:27], 0 offen offset:1024 sc1 nt lds
    v_add_u32 v234, s45, v234
    v_add_u32 v235, s45, v235
    s_waitcnt vmcnt(12)
    s_barrier
    ds_read_b128 v[80:83], v180 offset:16384
    ds_read_b128 v[84:87], v181 offset:16384
    ds_read_b128 v[88:91], v182 offset:16384
    ds_read_b128 v[92:95], v183 offset:16384
    v_mfma_f32_16x16x32_bf16 v[144:147], a[100:103], v[64:67], 0
    v_exp_f32 v128, v128
    v_mfma_f32_16x16x32_bf16 v[144:147], a[104:107], v[68:71], v[144:147]
    v_exp_f32 v129, v129
    v_mfma_f32_16x16x32_bf16 v[144:147], a[108:111], v[72:75], v[144:147]
    v_exp_f32 v130, v130
    v_mfma_f32_16x16x32_bf16 v[144:147], a[112:115], v[76:79], v[144:147]
    v_exp_f32 v131, v131
    v_mfma_f32_16x16x32_bf16 v[148:151], a[116:119], v[64:67], 0
    v_exp_f32 v132, v132
    v_mfma_f32_16x16x32_bf16 v[148:151], a[120:123], v[68:71], v[148:151]
    v_exp_f32 v133, v133
    v_mfma_f32_16x16x32_bf16 v[148:151], a[124:127], v[72:75], v[148:151]
    v_exp_f32 v134, v134
    v_mfma_f32_16x16x32_bf16 v[148:151], a[128:131], v[76:79], v[148:151]
    v_exp_f32 v135, v135
    v_cvt_pk_bf16_f32 v188, v128, v129
    v_cvt_pk_bf16_f32 v189, v130, v131
    v_cvt_pk_bf16_f32 v190, v132, v133
    v_cvt_pk_bf16_f32 v191, v134, v135
    s_waitcnt lgkmcnt(0)
    v_lshlrev_b32 v250, 16, v80
    v_and_b32 v251, s56, v80
    v_lshlrev_b32 v252, 16, v81
    v_and_b32 v253, s56, v81
    v_pk_mul_f32 v[250:251], v[250:251], s[42:43]
    v_pk_mul_f32 v[252:253], v[252:253], s[42:43]
    v_cvt_pk_bf16_f32 v80, v250, v251
    v_cvt_pk_bf16_f32 v81, v252, v253
    v_lshlrev_b32 v250, 16, v82
    v_and_b32 v251, s56, v82
    v_lshlrev_b32 v252, 16, v83
    v_and_b32 v253, s56, v83
    v_pk_mul_f32 v[250:251], v[250:251], s[42:43]
    v_pk_mul_f32 v[252:253], v[252:253], s[42:43]
    v_cvt_pk_bf16_f32 v82, v250, v251
    v_cvt_pk_bf16_f32 v83, v252, v253
    v_lshlrev_b32 v250, 16, v84
    v_and_b32 v251, s56, v84
    v_lshlrev_b32 v252, 16, v85
    v_and_b32 v253, s56, v85
    v_pk_mul_f32 v[250:251], v[250:251], s[42:43]
    v_pk_mul_f32 v[252:253], v[252:253], s[42:43]
    v_cvt_pk_bf16_f32 v84, v250, v251
    v_cvt_pk_bf16_f32 v85, v252, v253
    v_lshlrev_b32 v250, 16, v86
    v_and_b32 v251, s56, v86
    v_lshlrev_b32 v252, 16, v87
    v_and_b32 v253, s56, v87
    v_pk_mul_f32 v[250:251], v[250:251], s[42:43]
    v_pk_mul_f32 v[252:253], v[252:253], s[42:43]
    v_cvt_pk_bf16_f32 v86, v250, v251
    v_cvt_pk_bf16_f32 v87, v252, v253
    v_lshlrev_b32 v250, 16, v88
    v_and_b32 v251, s56, v88
    v_lshlrev_b32 v252, 16, v89
    v_and_b32 v253, s56, v89
    v_pk_mul_f32 v[250:251], v[250:251], s[42:43]
    v_pk_mul_f32 v[252:253], v[252:253], s[42:43]
    v_cvt_pk_bf16_f32 v88, v250, v251
    v_cvt_pk_bf16_f32 v89, v252, v253
    v_lshlrev_b32 v250, 16, v90
    v_and_b32 v251, s56, v90
    v_lshlrev_b32 v252, 16, v91
    v_and_b32 v253, s56, v91
    v_pk_mul_f32 v[250:251], v[250:251], s[42:43]
    v_pk_mul_f32 v[252:253], v[252:253], s[42:43]
    v_cvt_pk_bf16_f32 v90, v250, v251
    v_cvt_pk_bf16_f32 v91, v252, v253
    v_lshlrev_b32 v250, 16, v92
    v_and_b32 v251, s56, v92
    v_lshlrev_b32 v252, 16, v93
    v_and_b32 v253, s56, v93
    v_pk_mul_f32 v[250:251], v[250:251], s[42:43]
    v_pk_mul_f32 v[252:253], v[252:253], s[42:43]
    v_cvt_pk_bf16_f32 v92, v250, v251
    v_cvt_pk_bf16_f32 v93, v252, v253
    v_lshlrev_b32 v250, 16, v94
    v_and_b32 v251, s56, v94
    v_lshlrev_b32 v252, 16, v95
    v_and_b32 v253, s56, v95
    v_pk_mul_f32 v[250:251], v[250:251], s[42:43]
    v_pk_mul_f32 v[252:253], v[252:253], s[42:43]
    v_cvt_pk_bf16_f32 v94, v250, v251
    v_cvt_pk_bf16_f32 v95, v252, v253
    v_max3_f32 v254, v144, v145, v146
    v_max3_f32 v254, v254, v147, v148
    v_max3_f32 v254, v254, v149, v150
    v_max3_f32 v254, v254, v151, v243
    v_mov_b32 v255, v254
    s_nop 1
    v_permlane32_swap_b32 v254, v255
    v_max_f32 v254, v254, v255
    v_mov_b32 v255, v254
    s_nop 1
    v_permlane16_swap_b32 v254, v255
    v_max_f32 v254, v254, v255
    v_sub_f32 v144, v144, v254
    v_sub_f32 v145, v145, v254
    v_sub_f32 v146, v146, v254
    v_sub_f32 v147, v147, v254
    v_sub_f32 v148, v148, v254
    v_sub_f32 v149, v149, v254
    v_sub_f32 v150, v150, v254
    v_sub_f32 v151, v151, v254
    v_sub_f32 v212, 0, v254
    v_sub_f32 v213, 0, v254
    v_sub_f32 v214, 0, v254
    v_sub_f32 v215, 0, v254
    s_add_u32 m0, s37, 16384
    s_nop 0
    buffer_load_dwordx4 v232, s[12:15], 0 offen sc1 nt lds
    buffer_load_dwordx4 v233, s[12:15], 0 offen offset:1024 sc1 nt lds
    s_add_u32 m0, s37, 81920
    s_nop 0
    buffer_load_dwordx4 v232, s[16:19], 0 offen sc1 nt lds
    buffer_load_dwordx4 v233, s[16:19], 0 offen offset:1024 sc1 nt lds
    v_add_u32 v232, s45, v232
    v_add_u32 v233, s45, v233
    v_mfma_f32_16x16x32_bf16 v[160:163], a[100:103], v[80:83], 0
    v_exp_f32 v144, v144
    v_mfma_f32_16x16x32_bf16 v[160:163], a[104:107], v[84:87], v[160:163]
    v_exp_f32 v145, v145
    v_mfma_f32_16x16x32_bf16 v[160:163], a[108:111], v[88:91], v[160:163]
    v_exp_f32 v146, v146
    v_mfma_f32_16x16x32_bf16 v[160:163], a[112:115], v[92:95], v[160:163]
    v_exp_f32 v147, v147
    v_mfma_f32_16x16x32_bf16 v[164:167], a[116:119], v[80:83], 0
    v_exp_f32 v148, v148
    v_mfma_f32_16x16x32_bf16 v[164:167], a[120:123], v[84:87], v[164:167]
    v_exp_f32 v149, v149
    v_mfma_f32_16x16x32_bf16 v[164:167], a[124:127], v[88:91], v[164:167]
    v_exp_f32 v150, v150
    v_mfma_f32_16x16x32_bf16 v[164:167], a[128:131], v[92:95], v[164:167]
    v_exp_f32 v151, v151
    v_cvt_pk_bf16_f32 v196, v144, v145
    v_cvt_pk_bf16_f32 v197, v146, v147
    v_cvt_pk_bf16_f32 v198, v148, v149
    v_cvt_pk_bf16_f32 v199, v150, v151
    s_waitcnt vmcnt(12)
    s_barrier
    ds_read_b64_tr_b16 a[164:165], v224 offset:0
    ds_read_b64_tr_b16 a[166:167], v224 offset:4096
    ds_read_b64_tr_b16 a[168:169], v225 offset:0
    ds_read_b64_tr_b16 a[170:171], v225 offset:4096
    ds_read_b64_tr_b16 a[172:173], v226 offset:0
    ds_read_b64_tr_b16 a[174:175], v226 offset:4096
    ds_read_b64_tr_b16 a[176:177], v227 offset:0
    ds_read_b64_tr_b16 a[178:179], v227 offset:4096
    s_add_u32 m0, s41, 16384
    s_nop 0
    buffer_load_dwordx4 v234, s[20:23], 0 offen sc1 nt lds
    buffer_load_dwordx4 v235, s[20:23], 0 offen offset:1024 sc1 nt lds
    s_add_u32 m0, s41, 81920
    s_nop 0
    buffer_load_dwordx4 v234, s[24:27], 0 offen sc1 nt lds
    buffer_load_dwordx4 v235, s[24:27], 0 offen offset:1024 sc1 nt lds
    v_add_u32 v234, s45, v234
    v_add_u32 v235, s45, v235
    s_waitcnt lgkmcnt(4)
    ds_read_b64_tr_b16 a[180:181], v228 offset:0
    ds_read_b64_tr_b16 a[182:183], v228 offset:4096
    ds_read_b64_tr_b16 a[184:185], v229 offset:0
    ds_read_b64_tr_b16 a[186:187], v229 offset:4096
    ds_read_b64_tr_b16 a[188:189], v230 offset:0
    ds_read_b64_tr_b16 a[190:191], v230 offset:4096
    ds_read_b64_tr_b16 a[192:193], v231 offset:0
    ds_read_b64_tr_b16 a[194:195], v231 offset:4096
    v_max3_f32 v254, v160, v161, v162
    v_max3_f32 v254, v254, v163, v164
    v_max3_f32 v254, v254, v165, v166
    v_max3_f32 v254, v254, v167, v244
    v_mov_b32 v255, v254
    s_nop 1
    v_permlane32_swap_b32 v254, v255
    v_max_f32 v254, v254, v255
    v_mov_b32 v255, v254
    s_nop 1
    v_permlane16_swap_b32 v254, v255
    v_max_f32 v254, v254, v255
    s_waitcnt lgkmcnt(0)
    v_mfma_f32_16x16x32_bf16 v[96:99], a[164:167], v[192:195], 0
    v_sub_f32 v160, v160, v254
    v_mfma_f32_16x16x32_bf16 v[100:103], a[168:171], v[192:195], 0
    v_sub_f32 v161, v161, v254
    v_mfma_f32_16x16x32_bf16 v[104:107], a[172:175], v[192:195], 0
    v_sub_f32 v162, v162, v254
    v_mfma_f32_16x16x32_bf16 v[108:111], a[176:179], v[192:195], 0
    v_sub_f32 v163, v163, v254
    v_mfma_f32_16x16x32_bf16 a[0:3], a[180:183], v[192:195], 0
    v_sub_f32 v164, v164, v254
    v_mfma_f32_16x16x32_bf16 a[4:7], a[184:187], v[192:195], 0
    v_sub_f32 v165, v165, v254
    v_mfma_f32_16x16x32_bf16 a[8:11], a[188:191], v[192:195], 0
    v_sub_f32 v166, v166, v254
    v_mfma_f32_16x16x32_bf16 a[12:15], a[192:195], v[192:195], 0
    v_sub_f32 v167, v167, v254
    v_mfma_f32_16x16x32_bf16 a[80:83], v[236:239], v[192:195], 0
    v_sub_f32 v216, 0, v254
    v_mfma_f32_16x16x32_bf16 v[112:115], a[164:167], v[184:187], 0
    v_sub_f32 v217, 0, v254
    v_mfma_f32_16x16x32_bf16 v[116:119], a[168:171], v[184:187], 0
    v_sub_f32 v218, 0, v254
    v_mfma_f32_16x16x32_bf16 v[120:123], a[172:175], v[184:187], 0
    v_sub_f32 v219, 0, v254
    v_mfma_f32_16x16x32_bf16 v[124:127], a[176:179], v[184:187], 0
    v_mfma_f32_16x16x32_bf16 a[16:19], a[180:183], v[184:187], 0
    v_mfma_f32_16x16x32_bf16 a[20:23], a[184:187], v[184:187], 0
    v_mfma_f32_16x16x32_bf16 a[24:27], a[188:191], v[184:187], 0
    v_mfma_f32_16x16x32_bf16 a[28:31], a[192:195], v[184:187], 0
    v_mfma_f32_16x16x32_bf16 a[84:87], v[236:239], v[184:187], 0
    v_mfma_f32_16x16x32_bf16 v[128:131], a[164:167], v[188:191], 0
    v_mfma_f32_16x16x32_bf16 v[132:135], a[168:171], v[188:191], 0
    v_mfma_f32_16x16x32_bf16 v[136:139], a[172:175], v[188:191], 0
    v_mfma_f32_16x16x32_bf16 v[140:143], a[176:179], v[188:191], 0
    v_mfma_f32_16x16x32_bf16 a[32:35], a[180:183], v[188:191], 0
    v_mfma_f32_16x16x32_bf16 a[36:39], a[184:187], v[188:191], 0
    v_mfma_f32_16x16x32_bf16 a[40:43], a[188:191], v[188:191], 0
    v_mfma_f32_16x16x32_bf16 a[44:47], a[192:195], v[188:191], 0
    v_mfma_f32_16x16x32_bf16 a[88:91], v[236:239], v[188:191], 0
    s_waitcnt vmcnt(8)
    s_barrier
    ds_read_b128 a[132:135], v220 offset:8192
    ds_read_b128 a[136:139], v221 offset:8192
    ds_read_b128 a[140:143], v222 offset:8192
    ds_read_b128 a[144:147], v223 offset:8192
    ds_read_b128 a[148:151], v220 offset:12288
    ds_read_b128 a[152:155], v221 offset:12288
    ds_read_b128 a[156:159], v222 offset:12288
    ds_read_b128 a[160:163], v223 offset:12288
    s_add_u32 m0, s37, 24576
    s_nop 0
    buffer_load_dwordx4 v232, s[12:15], 0 offen sc1 nt lds
    buffer_load_dwordx4 v233, s[12:15], 0 offen offset:1024 sc1 nt lds
    s_add_u32 m0, s37, 90112
    s_nop 0
    buffer_load_dwordx4 v232, s[16:19], 0 offen sc1 nt lds
    buffer_load_dwordx4 v233, s[16:19], 0 offen offset:1024 sc1 nt lds
    v_add_u32 v232, s45, v232
    v_add_u32 v233, s45, v233
L_main:
    s_waitcnt lgkmcnt(0)
    v_mfma_f32_16x16x32_bf16 v[184:187], a[132:135], v[16:19], v[200:203]
    v_exp_f32 v160, v160
    v_mfma_f32_16x16x32_bf16 v[184:187], a[136:139], v[20:23], v[184:187]
    ds_read_b64_tr_b16 a[196:197], v224 offset:8192
    ds_read_b64_tr_b16 a[198:199], v224 offset:12288
    v_mfma_f32_16x16x32_bf16 v[184:187], a[140:143], v[24:27], v[184:187]
    v_exp_f32 v161, v161
    v_mfma_f32_16x16x32_bf16 v[184:187], a[144:147], v[28:31], v[184:187]
    s_add_u32 m0, s41, 24576
    ds_read_b64_tr_b16 a[200:201], v225 offset:8192
    ds_read_b64_tr_b16 a[202:203], v225 offset:12288
    v_cvt_pk_bf16_f32 v192, v160, v161
    v_mfma_f32_16x16x32_bf16 v[188:191], a[148:151], v[16:19], v[200:203]
    buffer_load_dwordx4 v234, s[20:23], 0 offen sc1 nt lds
    v_exp_f32 v162, v162
    v_mfma_f32_16x16x32_bf16 v[188:191], a[152:155], v[20:23], v[188:191]
    ds_read_b64_tr_b16 a[204:205], v226 offset:8192
    ds_read_b64_tr_b16 a[206:207], v226 offset:12288
    v_mfma_f32_16x16x32_bf16 v[188:191], a[156:159], v[24:27], v[188:191]
    buffer_load_dwordx4 v235, s[20:23], 0 offen offset:1024 sc1 nt lds
    v_exp_f32 v163, v163
    v_mfma_f32_16x16x32_bf16 v[188:191], a[160:163], v[28:31], v[188:191]
    ds_read_b64_tr_b16 a[208:209], v227 offset:8192
    ds_read_b64_tr_b16 a[210:211], v227 offset:12288
    v_cvt_pk_bf16_f32 v193, v162, v163
    v_mfma_f32_16x16x32_bf16 v[144:147], a[164:167], v[196:199], 0
    v_exp_f32 v164, v164
    v_mfma_f32_16x16x32_bf16 v[148:151], a[168:171], v[196:199], 0
    s_add_u32 m0, s41, 90112
    ds_read_b64_tr_b16 a[212:213], v228 offset:8192
    ds_read_b64_tr_b16 a[214:215], v228 offset:12288
    v_mfma_f32_16x16x32_bf16 v[152:155], a[172:175], v[196:199], 0
    buffer_load_dwordx4 v234, s[24:27], 0 offen sc1 nt lds
    v_exp_f32 v165, v165
    v_mfma_f32_16x16x32_bf16 v[156:159], a[176:179], v[196:199], 0
    ds_read_b64_tr_b16 a[216:217], v229 offset:8192
    ds_read_b64_tr_b16 a[218:219], v229 offset:12288
    v_cvt_pk_bf16_f32 v194, v164, v165
    v_mfma_f32_16x16x32_bf16 a[48:51], a[180:183], v[196:199], 0
    buffer_load_dwordx4 v235, s[24:27], 0 offen offset:1024 sc1 nt lds
    v_exp_f32 v166, v166
    v_mfma_f32_16x16x32_bf16 a[52:55], a[184:187], v[196:199], 0
    ds_read_b64_tr_b16 a[220:221], v230 offset:8192
    ds_read_b64_tr_b16 a[222:223], v230 offset:12288
    v_mfma_f32_16x16x32_bf16 a[56:59], a[188:191], v[196:199], 0
    v_exp_f32 v167, v167
    v_mfma_f32_16x16x32_bf16 a[60:63], a[192:195], v[196:199], 0
    ds_read_b64_tr_b16 a[224:225], v231 offset:8192
    ds_read_b64_tr_b16 a[226:227], v231 offset:12288
    v_cvt_pk_bf16_f32 v195, v166, v167
    v_mfma_f32_16x16x32_bf16 a[92:95], v[236:239], v[196:199], 0
    v_mfma_f32_16x16x32_bf16 v[176:179], a[132:135], v[32:35], v[204:207]
    s_waitcnt vmcnt(8) lgkmcnt(0)
    s_barrier
    v_exp_f32 v184, v184
    v_mfma_f32_16x16x32_bf16 v[176:179], a[136:139], v[36:39], v[176:179]
    ds_read_b128 a[100:103], v220 offset:16384
    v_add_u32 v234, s45, v234
    v_mfma_f32_16x16x32_bf16 v[176:179], a[140:143], v[40:43], v[176:179]
    v_exp_f32 v185, v185
    v_mfma_f32_16x16x32_bf16 v[176:179], a[144:147], v[44:47], v[176:179]
    v_cvt_pk_bf16_f32 v196, v184, v185
    v_mfma_f32_16x16x32_bf16 v[180:183], a[148:151], v[32:35], v[204:207]
    v_exp_f32 v186, v186
    v_mfma_f32_16x16x32_bf16 v[180:183], a[152:155], v[36:39], v[180:183]
    ds_read_b128 a[104:107], v221 offset:16384
    v_add_u32 v235, s45, v235
    v_mfma_f32_16x16x32_bf16 v[180:183], a[156:159], v[40:43], v[180:183]
    v_exp_f32 v187, v187
    v_mfma_f32_16x16x32_bf16 v[180:183], a[160:163], v[44:47], v[180:183]
    v_cvt_pk_bf16_f32 v197, v186, v187
    v_mfma_f32_16x16x32_bf16 v[160:163], a[164:167], v[192:195], 0
    v_exp_f32 v188, v188
    v_mfma_f32_16x16x32_bf16 v[164:167], a[168:171], v[192:195], 0
    ds_read_b128 a[108:111], v222 offset:16384
    v_mfma_f32_16x16x32_bf16 v[168:171], a[172:175], v[192:195], 0
    v_exp_f32 v189, v189
    v_mfma_f32_16x16x32_bf16 v[172:175], a[176:179], v[192:195], 0
    v_cvt_pk_bf16_f32 v198, v188, v189
    v_mfma_f32_16x16x32_bf16 a[64:67], a[180:183], v[192:195], 0
    s_add_u32 m0, s37, 0
    v_exp_f32 v190, v190
    v_mfma_f32_16x16x32_bf16 a[68:71], a[184:187], v[192:195], 0
    buffer_load_dwordx4 v232, s[12:15], 0 offen sc1 nt lds
    v_mfma_f32_16x16x32_bf16 a[72:75], a[188:191], v[192:195], 0
    v_exp_f32 v191, v191
    v_mfma_f32_16x16x32_bf16 a[76:79], a[192:195], v[192:195], 0
    v_cvt_pk_bf16_f32 v199, v190, v191
    v_mfma_f32_16x16x32_bf16 a[96:99], v[236:239], v[192:195], 0
    buffer_load_dwordx4 v233, s[12:15], 0 offen offset:1024 sc1 nt lds
    v_mfma_f32_16x16x32_bf16 v[184:187], a[132:135], v[48:51], v[208:211]
    v_exp_f32 v176, v176
    v_mfma_f32_16x16x32_bf16 v[184:187], a[136:139], v[52:55], v[184:187]
    ds_read_b128 a[112:115], v223 offset:16384
    v_mfma_f32_16x16x32_bf16 v[184:187], a[140:143], v[56:59], v[184:187]
    v_exp_f32 v177, v177
    v_mfma_f32_16x16x32_bf16 v[184:187], a[144:147], v[60:63], v[184:187]
    v_cvt_pk_bf16_f32 v192, v176, v177
    v_mfma_f32_16x16x32_bf16 v[188:191], a[148:151], v[48:51], v[208:211]
    v_exp_f32 v178, v178
    v_mfma_f32_16x16x32_bf16 v[188:191], a[152:155], v[52:55], v[188:191]
    ds_read_b128 a[116:119], v220 offset:20480
    v_mfma_f32_16x16x32_bf16 v[188:191], a[156:159], v[56:59], v[188:191]
    v_exp_f32 v179, v179
    v_mfma_f32_16x16x32_bf16 v[188:191], a[160:163], v[60:63], v[188:191]
    v_cvt_pk_bf16_f32 v193, v178, v179
    v_mfma_f32_16x16x32_bf16 v[96:99], a[196:199], v[196:199], v[96:99]
    v_exp_f32 v180, v180
    v_mfma_f32_16x16x32_bf16 v[100:103], a[200:203], v[196:199], v[100:103]
    ds_read_b64_tr_b16 a[164:165], v224 offset:16384
    ds_read_b64_tr_b16 a[166:167], v224 offset:20480
    v_mfma_f32_16x16x32_bf16 v[104:107], a[204:207], v[196:199], v[104:107]
    v_exp_f32 v181, v181
    v_mfma_f32_16x16x32_bf16 v[108:111], a[208:211], v[196:199], v[108:111]
    v_cvt_pk_bf16_f32 v194, v180, v181
    v_mfma_f32_16x16x32_bf16 a[0:3], a[212:215], v[196:199], a[0:3]
    v_exp_f32 v182, v182
    v_mfma_f32_16x16x32_bf16 a[4:7], a[216:219], v[196:199], a[4:7]
    ds_read_b64_tr_b16 a[168:169], v225 offset:16384
    ds_read_b64_tr_b16 a[170:171], v225 offset:20480
    v_mfma_f32_16x16x32_bf16 a[8:11], a[220:223], v[196:199], a[8:11]
    v_exp_f32 v183, v183
    v_mfma_f32_16x16x32_bf16 a[12:15], a[224:227], v[196:199], a[12:15]
    s_add_u32 m0, s37, 65536
    v_cvt_pk_bf16_f32 v195, v182, v183
    v_mfma_f32_16x16x32_bf16 a[80:83], v[236:239], v[196:199], a[80:83]
    buffer_load_dwordx4 v232, s[16:19], 0 offen sc1 nt lds
    v_mfma_f32_16x16x32_bf16 v[176:179], a[132:135], v[64:67], v[212:215]
    v_exp_f32 v184, v184
    v_mfma_f32_16x16x32_bf16 v[176:179], a[136:139], v[68:71], v[176:179]
    ds_read_b128 a[120:123], v221 offset:20480
    v_add_u32 v232, s45, v232
    v_mfma_f32_16x16x32_bf16 v[176:179], a[140:143], v[72:75], v[176:179]
    v_exp_f32 v185, v185
    v_mfma_f32_16x16x32_bf16 v[176:179], a[144:147], v[76:79], v[176:179]
    v_cvt_pk_bf16_f32 v196, v184, v185
    v_mfma_f32_16x16x32_bf16 v[180:183], a[148:151], v[64:67], v[212:215]
    v_exp_f32 v186, v186
    v_mfma_f32_16x16x32_bf16 v[180:183], a[152:155], v[68:71], v[180:183]
    ds_read_b128 a[124:127], v222 offset:20480
    v_mfma_f32_16x16x32_bf16 v[180:183], a[156:159], v[72:75], v[180:183]
    v_exp_f32 v187, v187
    v_mfma_f32_16x16x32_bf16 v[180:183], a[160:163], v[76:79], v[180:183]
    v_cvt_pk_bf16_f32 v197, v186, v187
    v_mfma_f32_16x16x32_bf16 v[112:115], a[196:199], v[192:195], v[112:115]
    v_exp_f32 v188, v188
    v_mfma_f32_16x16x32_bf16 v[116:119], a[200:203], v[192:195], v[116:119]
    ds_read_b64_tr_b16 a[172:173], v226 offset:16384
    ds_read_b64_tr_b16 a[174:175], v226 offset:20480
    v_mfma_f32_16x16x32_bf16 v[120:123], a[204:207], v[192:195], v[120:123]
    v_exp_f32 v189, v189
    v_mfma_f32_16x16x32_bf16 v[124:127], a[208:211], v[192:195], v[124:127]
    v_cvt_pk_bf16_f32 v198, v188, v189
    v_mfma_f32_16x16x32_bf16 a[16:19], a[212:215], v[192:195], a[16:19]
    v_exp_f32 v190, v190
    v_mfma_f32_16x16x32_bf16 a[20:23], a[216:219], v[192:195], a[20:23]
    ds_read_b64_tr_b16 a[176:177], v227 offset:16384
    ds_read_b64_tr_b16 a[178:179], v227 offset:20480
    v_mfma_f32_16x16x32_bf16 a[24:27], a[220:223], v[192:195], a[24:27]
    v_exp_f32 v191, v191
    v_mfma_f32_16x16x32_bf16 a[28:31], a[224:227], v[192:195], a[28:31]
    v_cvt_pk_bf16_f32 v199, v190, v191
    v_mfma_f32_16x16x32_bf16 a[84:87], v[236:239], v[192:195], a[84:87]
    buffer_load_dwordx4 v233, s[16:19], 0 offen offset:1024 sc1 nt lds
    v_mfma_f32_16x16x32_bf16 v[184:187], a[132:135], v[80:83], v[216:219]
    v_exp_f32 v176, v176
    v_mfma_f32_16x16x32_bf16 v[184:187], a[136:139], v[84:87], v[184:187]
    ds_read_b128 a[128:131], v223 offset:20480
    v_add_u32 v233, s45, v233
    v_mfma_f32_16x16x32_bf16 v[184:187], a[140:143], v[88:91], v[184:187]
    v_exp_f32 v177, v177
    v_mfma_f32_16x16x32_bf16 v[184:187], a[144:147], v[92:95], v[184:187]
    v_cvt_pk_bf16_f32 v192, v176, v177
    v_mfma_f32_16x16x32_bf16 v[188:191], a[148:151], v[80:83], v[216:219]
    v_exp_f32 v178, v178
    v_mfma_f32_16x16x32_bf16 v[188:191], a[152:155], v[84:87], v[188:191]
    ds_read_b64_tr_b16 a[180:181], v228 offset:16384
    ds_read_b64_tr_b16 a[182:183], v228 offset:20480
    v_mfma_f32_16x16x32_bf16 v[188:191], a[156:159], v[88:91], v[188:191]
    v_exp_f32 v179, v179
    v_mfma_f32_16x16x32_bf16 v[188:191], a[160:163], v[92:95], v[188:191]
    v_cvt_pk_bf16_f32 v193, v178, v179
    v_mfma_f32_16x16x32_bf16 v[128:131], a[196:199], v[196:199], v[128:131]
    v_exp_f32 v180, v180
    v_mfma_f32_16x16x32_bf16 v[132:135], a[200:203], v[196:199], v[132:135]
    ds_read_b64_tr_b16 a[184:185], v229 offset:16384
    ds_read_b64_tr_b16 a[186:187], v229 offset:20480
    v_mfma_f32_16x16x32_bf16 v[136:139], a[204:207], v[196:199], v[136:139]
    v_exp_f32 v181, v181
    v_mfma_f32_16x16x32_bf16 v[140:143], a[208:211], v[196:199], v[140:143]
    v_cvt_pk_bf16_f32 v194, v180, v181
    v_mfma_f32_16x16x32_bf16 a[32:35], a[212:215], v[196:199], a[32:35]
    v_exp_f32 v182, v182
    v_mfma_f32_16x16x32_bf16 a[36:39], a[216:219], v[196:199], a[36:39]
    ds_read_b64_tr_b16 a[188:189], v230 offset:16384
    ds_read_b64_tr_b16 a[190:191], v230 offset:20480
    v_mfma_f32_16x16x32_bf16 a[40:43], a[220:223], v[196:199], a[40:43]
    v_exp_f32 v183, v183
    v_mfma_f32_16x16x32_bf16 a[44:47], a[224:227], v[196:199], a[44:47]
    s_add_u32 m0, s41, 0
    v_cvt_pk_bf16_f32 v195, v182, v183
    v_mfma_f32_16x16x32_bf16 a[88:91], v[236:239], v[196:199], a[88:91]
    s_waitcnt lgkmcnt(6)
    buffer_load_dwordx4 v234, s[20:23], 0 offen sc1 nt lds
    v_mfma_f32_16x16x32_bf16 v[176:179], a[100:103], v[16:19], v[200:203]
    v_exp_f32 v184, v184
    v_mfma_f32_16x16x32_bf16 v[176:179], a[104:107], v[20:23], v[176:179]
    ds_read_b64_tr_b16 a[192:193], v231 offset:16384
    ds_read_b64_tr_b16 a[194:195], v231 offset:20480
    v_mfma_f32_16x16x32_bf16 v[176:179], a[108:111], v[24:27], v[176:179]
    v_exp_f32 v185, v185
    v_mfma_f32_16x16x32_bf16 v[176:179], a[112:115], v[28:31], v[176:179]
    v_cvt_pk_bf16_f32 v196, v184, v185
    v_mfma_f32_16x16x32_bf16 v[180:183], a[116:119], v[16:19], v[200:203]
    v_exp_f32 v186, v186
    v_mfma_f32_16x16x32_bf16 v[180:183], a[120:123], v[20:23], v[180:183]
    buffer_load_dwordx4 v235, s[20:23], 0 offen offset:1024 sc1 nt lds
    v_mfma_f32_16x16x32_bf16 v[180:183], a[124:127], v[24:27], v[180:183]
    v_exp_f32 v187, v187
    v_mfma_f32_16x16x32_bf16 v[180:183], a[128:131], v[28:31], v[180:183]
    v_cvt_pk_bf16_f32 v197, v186, v187
    v_mfma_f32_16x16x32_bf16 v[144:147], a[196:199], v[192:195], v[144:147]
    s_add_u32 m0, s41, 65536
    v_exp_f32 v188, v188
    v_mfma_f32_16x16x32_bf16 v[148:151], a[200:203], v[192:195], v[148:151]
    buffer_load_dwordx4 v234, s[24:27], 0 offen sc1 nt lds
    v_mfma_f32_16x16x32_bf16 v[152:155], a[204:207], v[192:195], v[152:155]
    v_exp_f32 v189, v189
    v_mfma_f32_16x16x32_bf16 v[156:159], a[208:211], v[192:195], v[156:159]
    v_cvt_pk_bf16_f32 v198, v188, v189
    v_mfma_f32_16x16x32_bf16 a[48:51], a[212:215], v[192:195], a[48:51]
    v_exp_f32 v190, v190
    v_mfma_f32_16x16x32_bf16 a[52:55], a[216:219], v[192:195], a[52:55]
    buffer_load_dwordx4 v235, s[24:27], 0 offen offset:1024 sc1 nt lds
    v_mfma_f32_16x16x32_bf16 a[56:59], a[220:223], v[192:195], a[56:59]
    v_exp_f32 v191, v191
    v_mfma_f32_16x16x32_bf16 a[60:63], a[224:227], v[192:195], a[60:63]
    s_waitcnt lgkmcnt(0)
    v_cvt_pk_bf16_f32 v199, v190, v191
    v_mfma_f32_16x16x32_bf16 a[92:95], v[236:239], v[192:195], a[92:95]
    s_mov_b32 s40, 7
L_loop:
    v_mfma_f32_16x16x32_bf16 v[184:187], a[100:103], v[32:35], v[204:207]
    s_waitcnt vmcnt(8)
    s_barrier
    v_exp_f32 v176, v176
    v_mfma_f32_16x16x32_bf16 v[184:187], a[104:107], v[36:39], v[184:187]
    ds_read_b128 a[132:135], v220 offset:24576
    v_add_u32 v234, s45, v234
    v_mfma_f32_16x16x32_bf16 v[184:187], a[108:111], v[40:43], v[184:187]
    v_exp_f32 v177, v177
    v_mfma_f32_16x16x32_bf16 v[184:187], a[112:115], v[44:47], v[184:187]
    v_cvt_pk_bf16_f32 v192, v176, v177
    v_mfma_f32_16x16x32_bf16 v[188:191], a[116:119], v[32:35], v[204:207]
    v_exp_f32 v178, v178
    v_mfma_f32_16x16x32_bf16 v[188:191], a[120:123], v[36:39], v[188:191]
    ds_read_b128 a[136:139], v221 offset:24576
    v_add_u32 v235, s45, v235
    v_mfma_f32_16x16x32_bf16 v[188:191], a[124:127], v[40:43], v[188:191]
    v_exp_f32 v179, v179
    v_mfma_f32_16x16x32_bf16 v[188:191], a[128:131], v[44:47], v[188:191]
    v_cvt_pk_bf16_f32 v193, v178, v179
    v_mfma_f32_16x16x32_bf16 v[160:163], a[196:199], v[196:199], v[160:163]
    v_exp_f32 v180, v180
    v_mfma_f32_16x16x32_bf16 v[164:167], a[200:203], v[196:199], v[164:167]
    ds_read_b128 a[140:143], v222 offset:24576
    v_mfma_f32_16x16x32_bf16 v[168:171], a[204:207], v[196:199], v[168:171]
    v_exp_f32 v181, v181
    v_mfma_f32_16x16x32_bf16 v[172:175], a[208:211], v[196:199], v[172:175]
    v_cvt_pk_bf16_f32 v194, v180, v181
    v_mfma_f32_16x16x32_bf16 a[64:67], a[212:215], v[196:199], a[64:67]
    s_add_u32 m0, s37, 8192
    v_exp_f32 v182, v182
    v_mfma_f32_16x16x32_bf16 a[68:71], a[216:219], v[196:199], a[68:71]
    buffer_load_dwordx4 v232, s[12:15], 0 offen sc1 nt lds
    v_mfma_f32_16x16x32_bf16 a[72:75], a[220:223], v[196:199], a[72:75]
    v_exp_f32 v183, v183
    v_mfma_f32_16x16x32_bf16 a[76:79], a[224:227], v[196:199], a[76:79]
    v_cvt_pk_bf16_f32 v195, v182, v183
    v_mfma_f32_16x16x32_bf16 a[96:99], v[236:239], v[196:199], a[96:99]
    buffer_load_dwordx4 v233, s[12:15], 0 offen offset:1024 sc1 nt lds
    v_mfma_f32_16x16x32_bf16 v[176:179], a[100:103], v[48:51], v[208:211]
    v_exp_f32 v184, v184
    v_mfma_f32_16x16x32_bf16 v[176:179], a[104:107], v[52:55], v[176:179]
    ds_read_b128 a[144:147], v223 offset:24576
    v_mfma_f32_16x16x32_bf16 v[176:179], a[108:111], v[56:59], v[176:179]
    v_exp_f32 v185, v185
    v_mfma_f32_16x16x32_bf16 v[176:179], a[112:115], v[60:63], v[176:179]
    v_cvt_pk_bf16_f32 v196, v184, v185
    v_mfma_f32_16x16x32_bf16 v[180:183], a[116:119], v[48:51], v[208:211]
    v_exp_f32 v186, v186
    v_mfma_f32_16x16x32_bf16 v[180:183], a[120:123], v[52:55], v[180:183]
    ds_read_b128 a[148:151], v220 offset:28672
    v_mfma_f32_16x16x32_bf16 v[180:183], a[124:127], v[56:59], v[180:183]
    v_exp_f32 v187, v187
    v_mfma_f32_16x16x32_bf16 v[180:183], a[128:131], v[60:63], v[180:183]
    v_cvt_pk_bf16_f32 v197, v186, v187
    v_mfma_f32_16x16x32_bf16 v[96:99], a[164:167], v[192:195], v[96:99]
    v_exp_f32 v188, v188
    v_mfma_f32_16x16x32_bf16 v[100:103], a[168:171], v[192:195], v[100:103]
    ds_read_b64_tr_b16 a[196:197], v224 offset:24576
    ds_read_b64_tr_b16 a[198:199], v224 offset:28672
    v_mfma_f32_16x16x32_bf16 v[104:107], a[172:175], v[192:195], v[104:107]
    v_exp_f32 v189, v189
    v_mfma_f32_16x16x32_bf16 v[108:111], a[176:179], v[192:195], v[108:111]
    v_cvt_pk_bf16_f32 v198, v188, v189
    v_mfma_f32_16x16x32_bf16 a[0:3], a[180:183], v[192:195], a[0:3]
    v_exp_f32 v190, v190
    v_mfma_f32_16x16x32_bf16 a[4:7], a[184:187], v[192:195], a[4:7]
    ds_read_b64_tr_b16 a[200:201], v225 offset:24576
    ds_read_b64_tr_b16 a[202:203], v225 offset:28672
    v_mfma_f32_16x16x32_bf16 a[8:11], a[188:191], v[192:195], a[8:11]
    v_exp_f32 v191, v191
    v_mfma_f32_16x16x32_bf16 a[12:15], a[192:195], v[192:195], a[12:15]
    s_add_u32 m0, s37, 73728
    v_cvt_pk_bf16_f32 v199, v190, v191
    v_mfma_f32_16x16x32_bf16 a[80:83], v[236:239], v[192:195], a[80:83]
    buffer_load_dwordx4 v232, s[16:19], 0 offen sc1 nt lds
    v_mfma_f32_16x16x32_bf16 v[184:187], a[100:103], v[64:67], v[212:215]
    v_exp_f32 v176, v176
    v_mfma_f32_16x16x32_bf16 v[184:187], a[104:107], v[68:71], v[184:187]
    ds_read_b128 a[152:155], v221 offset:28672
    v_add_u32 v232, s45, v232
    v_mfma_f32_16x16x32_bf16 v[184:187], a[108:111], v[72:75], v[184:187]
    v_exp_f32 v177, v177
    v_mfma_f32_16x16x32_bf16 v[184:187], a[112:115], v[76:79], v[184:187]
    v_cvt_pk_bf16_f32 v192, v176, v177
    v_mfma_f32_16x16x32_bf16 v[188:191], a[116:119], v[64:67], v[212:215]
    v_exp_f32 v178, v178
    v_mfma_f32_16x16x32_bf16 v[188:191], a[120:123], v[68:71], v[188:191]
    ds_read_b128 a[156:159], v222 offset:28672
    v_mfma_f32_16x16x32_bf16 v[188:191], a[124:127], v[72:75], v[188:191]
    v_exp_f32 v179, v179
    v_mfma_f32_16x16x32_bf16 v[188:191], a[128:131], v[76:79], v[188:191]
    v_cvt_pk_bf16_f32 v193, v178, v179
    v_mfma_f32_16x16x32_bf16 v[112:115], a[164:167], v[196:199], v[112:115]
    v_exp_f32 v180, v180
    v_mfma_f32_16x16x32_bf16 v[116:119], a[168:171], v[196:199], v[116:119]
    ds_read_b64_tr_b16 a[204:205], v226 offset:24576
    ds_read_b64_tr_b16 a[206:207], v226 offset:28672
    v_mfma_f32_16x16x32_bf16 v[120:123], a[172:175], v[196:199], v[120:123]
    v_exp_f32 v181, v181
    v_mfma_f32_16x16x32_bf16 v[124:127], a[176:179], v[196:199], v[124:127]
    v_cvt_pk_bf16_f32 v194, v180, v181
    v_mfma_f32_16x16x32_bf16 a[16:19], a[180:183], v[196:199], a[16:19]
    v_exp_f32 v182, v182
    v_mfma_f32_16x16x32_bf16 a[20:23], a[184:187], v[196:199], a[20:23]
    ds_read_b64_tr_b16 a[208:209], v227 offset:24576
    ds_read_b64_tr_b16 a[210:211], v227 offset:28672
    v_mfma_f32_16x16x32_bf16 a[24:27], a[188:191], v[196:199], a[24:27]
    v_exp_f32 v183, v183
    v_mfma_f32_16x16x32_bf16 a[28:31], a[192:195], v[196:199], a[28:31]
    v_cvt_pk_bf16_f32 v195, v182, v183
    v_mfma_f32_16x16x32_bf16 a[84:87], v[236:239], v[196:199], a[84:87]
    buffer_load_dwordx4 v233, s[16:19], 0 offen offset:1024 sc1 nt lds
    v_mfma_f32_16x16x32_bf16 v[176:179], a[100:103], v[80:83], v[216:219]
    v_exp_f32 v184, v184
    v_mfma_f32_16x16x32_bf16 v[176:179], a[104:107], v[84:87], v[176:179]
    ds_read_b128 a[160:163], v223 offset:28672
    v_add_u32 v233, s45, v233
    v_mfma_f32_16x16x32_bf16 v[176:179], a[108:111], v[88:91], v[176:179]
    v_exp_f32 v185, v185
    v_mfma_f32_16x16x32_bf16 v[176:179], a[112:115], v[92:95], v[176:179]
    v_cvt_pk_bf16_f32 v196, v184, v185
    v_mfma_f32_16x16x32_bf16 v[180:183], a[116:119], v[80:83], v[216:219]
    v_exp_f32 v186, v186
    v_mfma_f32_16x16x32_bf16 v[180:183], a[120:123], v[84:87], v[180:183]
    ds_read_b64_tr_b16 a[212:213], v228 offset:24576
    ds_read_b64_tr_b16 a[214:215], v228 offset:28672
    v_mfma_f32_16x16x32_bf16 v[180:183], a[124:127], v[88:91], v[180:183]
    v_exp_f32 v187, v187
    v_mfma_f32_16x16x32_bf16 v[180:183], a[128:131], v[92:95], v[180:183]
    v_cvt_pk_bf16_f32 v197, v186, v187
    v_mfma_f32_16x16x32_bf16 v[128:131], a[164:167], v[192:195], v[128:131]
    v_exp_f32 v188, v188
    v_mfma_f32_16x16x32_bf16 v[132:135], a[168:171], v[192:195], v[132:135]
    ds_read_b64_tr_b16 a[216:217], v229 offset:24576
    ds_read_b64_tr_b16 a[218:219], v229 offset:28672
    v_mfma_f32_16x16x32_bf16 v[136:139], a[172:175], v[192:195], v[136:139]
    v_exp_f32 v189, v189
    v_mfma_f32_16x16x32_bf16 v[140:143], a[176:179], v[192:195], v[140:143]
    v_cvt_pk_bf16_f32 v198, v188, v189
    v_mfma_f32_16x16x32_bf16 a[32:35], a[180:183], v[192:195], a[32:35]
    v_exp_f32 v190, v190
    v_mfma_f32_16x16x32_bf16 a[36:39], a[184:187], v[192:195], a[36:39]
    ds_read_b64_tr_b16 a[220:221], v230 offset:24576
    ds_read_b64_tr_b16 a[222:223], v230 offset:28672
    v_mfma_f32_16x16x32_bf16 a[40:43], a[188:191], v[192:195], a[40:43]
    v_exp_f32 v191, v191
    v_mfma_f32_16x16x32_bf16 a[44:47], a[192:195], v[192:195], a[44:47]
    s_add_u32 m0, s41, 8192
    v_cvt_pk_bf16_f32 v199, v190, v191
    v_mfma_f32_16x16x32_bf16 a[88:91], v[236:239], v[192:195], a[88:91]
    s_waitcnt lgkmcnt(6)
    buffer_load_dwordx4 v234, s[20:23], 0 offen sc1 nt lds
    v_mfma_f32_16x16x32_bf16 v[184:187], a[132:135], v[16:19], v[200:203]
    v_exp_f32 v176, v176
    v_mfma_f32_16x16x32_bf16 v[184:187], a[136:139], v[20:23], v[184:187]
    ds_read_b64_tr_b16 a[224:225], v231 offset:24576
    ds_read_b64_tr_b16 a[226:227], v231 offset:28672
    v_mfma_f32_16x16x32_bf16 v[184:187], a[140:143], v[24:27], v[184:187]
    v_exp_f32 v177, v177
    v_mfma_f32_16x16x32_bf16 v[184:187], a[144:147], v[28:31], v[184:187]
    v_cvt_pk_bf16_f32 v192, v176, v177
    v_mfma_f32_16x16x32_bf16 v[188:191], a[148:151], v[16:19], v[200:203]
    v_exp_f32 v178, v178
    v_mfma_f32_16x16x32_bf16 v[188:191], a[152:155], v[20:23], v[188:191]
    buffer_load_dwordx4 v235, s[20:23], 0 offen offset:1024 sc1 nt lds
    v_mfma_f32_16x16x32_bf16 v[188:191], a[156:159], v[24:27], v[188:191]
    v_exp_f32 v179, v179
    v_mfma_f32_16x16x32_bf16 v[188:191], a[160:163], v[28:31], v[188:191]
    v_cvt_pk_bf16_f32 v193, v178, v179
    v_mfma_f32_16x16x32_bf16 v[144:147], a[164:167], v[196:199], v[144:147]
    s_add_u32 m0, s41, 73728
    v_exp_f32 v180, v180
    v_mfma_f32_16x16x32_bf16 v[148:151], a[168:171], v[196:199], v[148:151]
    buffer_load_dwordx4 v234, s[24:27], 0 offen sc1 nt lds
    v_mfma_f32_16x16x32_bf16 v[152:155], a[172:175], v[196:199], v[152:155]
    v_exp_f32 v181, v181
    v_mfma_f32_16x16x32_bf16 v[156:159], a[176:179], v[196:199], v[156:159]
    v_cvt_pk_bf16_f32 v194, v180, v181
    v_mfma_f32_16x16x32_bf16 a[48:51], a[180:183], v[196:199], a[48:51]
    v_exp_f32 v182, v182
    v_mfma_f32_16x16x32_bf16 a[52:55], a[184:187], v[196:199], a[52:55]
    buffer_load_dwordx4 v235, s[24:27], 0 offen offset:1024 sc1 nt lds
    v_mfma_f32_16x16x32_bf16 a[56:59], a[188:191], v[196:199], a[56:59]
    v_exp_f32 v183, v183
    v_mfma_f32_16x16x32_bf16 a[60:63], a[192:195], v[196:199], a[60:63]
    s_waitcnt lgkmcnt(0)
    v_cvt_pk_bf16_f32 v195, v182, v183
    v_mfma_f32_16x16x32_bf16 a[92:95], v[236:239], v[196:199], a[92:95]
    v_mfma_f32_16x16x32_bf16 v[176:179], a[132:135], v[32:35], v[204:207]
    s_waitcnt vmcnt(8)
    s_barrier
    v_exp_f32 v184, v184
    v_mfma_f32_16x16x32_bf16 v[176:179], a[136:139], v[36:39], v[176:179]
    ds_read_b128 a[100:103], v220 offset:0
    v_add_u32 v234, s45, v234
    v_mfma_f32_16x16x32_bf16 v[176:179], a[140:143], v[40:43], v[176:179]
    v_exp_f32 v185, v185
    v_mfma_f32_16x16x32_bf16 v[176:179], a[144:147], v[44:47], v[176:179]
    v_cvt_pk_bf16_f32 v196, v184, v185
    v_mfma_f32_16x16x32_bf16 v[180:183], a[148:151], v[32:35], v[204:207]
    v_exp_f32 v186, v186
    v_mfma_f32_16x16x32_bf16 v[180:183], a[152:155], v[36:39], v[180:183]
    ds_read_b128 a[104:107], v221 offset:0
    v_add_u32 v235, s45, v235
    v_mfma_f32_16x16x32_bf16 v[180:183], a[156:159], v[40:43], v[180:183]
    v_exp_f32 v187, v187
    v_mfma_f32_16x16x32_bf16 v[180:183], a[160:163], v[44:47], v[180:183]
    v_cvt_pk_bf16_f32 v197, v186, v187
    v_mfma_f32_16x16x32_bf16 v[160:163], a[164:167], v[192:195], v[160:163]
    v_exp_f32 v188, v188
    v_mfma_f32_16x16x32_bf16 v[164:167], a[168:171], v[192:195], v[164:167]
    ds_read_b128 a[108:111], v222 offset:0
    v_mfma_f32_16x16x32_bf16 v[168:171], a[172:175], v[192:195], v[168:171]
    v_exp_f32 v189, v189
    v_mfma_f32_16x16x32_bf16 v[172:175], a[176:179], v[192:195], v[172:175]
    v_cvt_pk_bf16_f32 v198, v188, v189
    v_mfma_f32_16x16x32_bf16 a[64:67], a[180:183], v[192:195], a[64:67]
    s_add_u32 m0, s37, 16384
    v_exp_f32 v190, v190
    v_mfma_f32_16x16x32_bf16 a[68:71], a[184:187], v[192:195], a[68:71]
    buffer_load_dwordx4 v232, s[12:15], 0 offen sc1 nt lds
    v_mfma_f32_16x16x32_bf16 a[72:75], a[188:191], v[192:195], a[72:75]
    v_exp_f32 v191, v191
    v_mfma_f32_16x16x32_bf16 a[76:79], a[192:195], v[192:195], a[76:79]
    v_cvt_pk_bf16_f32 v199, v190, v191
    v_mfma_f32_16x16x32_bf16 a[96:99], v[236:239], v[192:195], a[96:99]
    buffer_load_dwordx4 v233, s[12:15], 0 offen offset:1024 sc1 nt lds
    v_mfma_f32_16x16x32_bf16 v[184:187], a[132:135], v[48:51], v[208:211]
    v_exp_f32 v176, v176
    v_mfma_f32_16x16x32_bf16 v[184:187], a[136:139], v[52:55], v[184:187]
    ds_read_b128 a[112:115], v223 offset:0
    v_mfma_f32_16x16x32_bf16 v[184:187], a[140:143], v[56:59], v[184:187]
    v_exp_f32 v177, v177
    v_mfma_f32_16x16x32_bf16 v[184:187], a[144:147], v[60:63], v[184:187]
    v_cvt_pk_bf16_f32 v192, v176, v177
    v_mfma_f32_16x16x32_bf16 v[188:191], a[148:151], v[48:51], v[208:211]
    v_exp_f32 v178, v178
    v_mfma_f32_16x16x32_bf16 v[188:191], a[152:155], v[52:55], v[188:191]
    ds_read_b128 a[116:119], v220 offset:4096
    v_mfma_f32_16x16x32_bf16 v[188:191], a[156:159], v[56:59], v[188:191]
    v_exp_f32 v179, v179
    v_mfma_f32_16x16x32_bf16 v[188:191], a[160:163], v[60:63], v[188:191]
    v_cvt_pk_bf16_f32 v193, v178, v179
    v_mfma_f32_16x16x32_bf16 v[96:99], a[196:199], v[196:199], v[96:99]
    v_exp_f32 v180, v180
    v_mfma_f32_16x16x32_bf16 v[100:103], a[200:203], v[196:199], v[100:103]
    ds_read_b64_tr_b16 a[164:165], v224 offset:0
    ds_read_b64_tr_b16 a[166:167], v224 offset:4096
    v_mfma_f32_16x16x32_bf16 v[104:107], a[204:207], v[196:199], v[104:107]
    v_exp_f32 v181, v181
    v_mfma_f32_16x16x32_bf16 v[108:111], a[208:211], v[196:199], v[108:111]
    v_cvt_pk_bf16_f32 v194, v180, v181
    v_mfma_f32_16x16x32_bf16 a[0:3], a[212:215], v[196:199], a[0:3]
    v_exp_f32 v182, v182
    v_mfma_f32_16x16x32_bf16 a[4:7], a[216:219], v[196:199], a[4:7]
    ds_read_b64_tr_b16 a[168:169], v225 offset:0
    ds_read_b64_tr_b16 a[170:171], v225 offset:4096
    v_mfma_f32_16x16x32_bf16 a[8:11], a[220:223], v[196:199], a[8:11]
    v_exp_f32 v183, v183
    v_mfma_f32_16x16x32_bf16 a[12:15], a[224:227], v[196:199], a[12:15]
    s_add_u32 m0, s37, 81920
    v_cvt_pk_bf16_f32 v195, v182, v183
    v_mfma_f32_16x16x32_bf16 a[80:83], v[236:239], v[196:199], a[80:83]
    buffer_load_dwordx4 v232, s[16:19], 0 offen sc1 nt lds
    v_mfma_f32_16x16x32_bf16 v[176:179], a[132:135], v[64:67], v[212:215]
    v_exp_f32 v184, v184
    v_mfma_f32_16x16x32_bf16 v[176:179], a[136:139], v[68:71], v[176:179]
    ds_read_b128 a[120:123], v221 offset:4096
    v_add_u32 v232, s45, v232
    v_mfma_f32_16x16x32_bf16 v[176:179], a[140:143], v[72:75], v[176:179]
    v_exp_f32 v185, v185
    v_mfma_f32_16x16x32_bf16 v[176:179], a[144:147], v[76:79], v[176:179]
    v_cvt_pk_bf16_f32 v196, v184, v185
    v_mfma_f32_16x16x32_bf16 v[180:183], a[148:151], v[64:67], v[212:215]
    v_exp_f32 v186, v186
    v_mfma_f32_16x16x32_bf16 v[180:183], a[152:155], v[68:71], v[180:183]
    ds_read_b128 a[124:127], v222 offset:4096
    v_mfma_f32_16x16x32_bf16 v[180:183], a[156:159], v[72:75], v[180:183]
    v_exp_f32 v187, v187
    v_mfma_f32_16x16x32_bf16 v[180:183], a[160:163], v[76:79], v[180:183]
    v_cvt_pk_bf16_f32 v197, v186, v187
    v_mfma_f32_16x16x32_bf16 v[112:115], a[196:199], v[192:195], v[112:115]
    v_exp_f32 v188, v188
    v_mfma_f32_16x16x32_bf16 v[116:119], a[200:203], v[192:195], v[116:119]
    ds_read_b64_tr_b16 a[172:173], v226 offset:0
    ds_read_b64_tr_b16 a[174:175], v226 offset:4096
    v_mfma_f32_16x16x32_bf16 v[120:123], a[204:207], v[192:195], v[120:123]
    v_exp_f32 v189, v189
    v_mfma_f32_16x16x32_bf16 v[124:127], a[208:211], v[192:195], v[124:127]
    v_cvt_pk_bf16_f32 v198, v188, v189
    v_mfma_f32_16x16x32_bf16 a[16:19], a[212:215], v[192:195], a[16:19]
    v_exp_f32 v190, v190
    v_mfma_f32_16x16x32_bf16 a[20:23], a[216:219], v[192:195], a[20:23]
    ds_read_b64_tr_b16 a[176:177], v227 offset:0
    ds_read_b64_tr_b16 a[178:179], v227 offset:4096
    v_mfma_f32_16x16x32_bf16 a[24:27], a[220:223], v[192:195], a[24:27]
    v_exp_f32 v191, v191
    v_mfma_f32_16x16x32_bf16 a[28:31], a[224:227], v[192:195], a[28:31]
    v_cvt_pk_bf16_f32 v199, v190, v191
    v_mfma_f32_16x16x32_bf16 a[84:87], v[236:239], v[192:195], a[84:87]
    buffer_load_dwordx4 v233, s[16:19], 0 offen offset:1024 sc1 nt lds
    v_mfma_f32_16x16x32_bf16 v[184:187], a[132:135], v[80:83], v[216:219]
    v_exp_f32 v176, v176
    v_mfma_f32_16x16x32_bf16 v[184:187], a[136:139], v[84:87], v[184:187]
    ds_read_b128 a[128:131], v223 offset:4096
    v_add_u32 v233, s45, v233
    v_mfma_f32_16x16x32_bf16 v[184:187], a[140:143], v[88:91], v[184:187]
    v_exp_f32 v177, v177
    v_mfma_f32_16x16x32_bf16 v[184:187], a[144:147], v[92:95], v[184:187]
    v_cvt_pk_bf16_f32 v192, v176, v177
    v_mfma_f32_16x16x32_bf16 v[188:191], a[148:151], v[80:83], v[216:219]
    v_exp_f32 v178, v178
    v_mfma_f32_16x16x32_bf16 v[188:191], a[152:155], v[84:87], v[188:191]
    ds_read_b64_tr_b16 a[180:181], v228 offset:0
    ds_read_b64_tr_b16 a[182:183], v228 offset:4096
    v_mfma_f32_16x16x32_bf16 v[188:191], a[156:159], v[88:91], v[188:191]
    v_exp_f32 v179, v179
    v_mfma_f32_16x16x32_bf16 v[188:191], a[160:163], v[92:95], v[188:191]
    v_cvt_pk_bf16_f32 v193, v178, v179
    v_mfma_f32_16x16x32_bf16 v[128:131], a[196:199], v[196:199], v[128:131]
    v_exp_f32 v180, v180
    v_mfma_f32_16x16x32_bf16 v[132:135], a[200:203], v[196:199], v[132:135]
    ds_read_b64_tr_b16 a[184:185], v229 offset:0
    ds_read_b64_tr_b16 a[186:187], v229 offset:4096
    v_mfma_f32_16x16x32_bf16 v[136:139], a[204:207], v[196:199], v[136:139]
    v_exp_f32 v181, v181
    v_mfma_f32_16x16x32_bf16 v[140:143], a[208:211], v[196:199], v[140:143]
    v_cvt_pk_bf16_f32 v194, v180, v181
    v_mfma_f32_16x16x32_bf16 a[32:35], a[212:215], v[196:199], a[32:35]
    v_exp_f32 v182, v182
    v_mfma_f32_16x16x32_bf16 a[36:39], a[216:219], v[196:199], a[36:39]
    ds_read_b64_tr_b16 a[188:189], v230 offset:0
    ds_read_b64_tr_b16 a[190:191], v230 offset:4096
    v_mfma_f32_16x16x32_bf16 a[40:43], a[220:223], v[196:199], a[40:43]
    v_exp_f32 v183, v183
    v_mfma_f32_16x16x32_bf16 a[44:47], a[224:227], v[196:199], a[44:47]
    s_add_u32 m0, s41, 16384
    v_cvt_pk_bf16_f32 v195, v182, v183
    v_mfma_f32_16x16x32_bf16 a[88:91], v[236:239], v[196:199], a[88:91]
    s_waitcnt lgkmcnt(6)
    buffer_load_dwordx4 v234, s[20:23], 0 offen sc1 nt lds
    v_mfma_f32_16x16x32_bf16 v[176:179], a[100:103], v[16:19], v[200:203]
    v_exp_f32 v184, v184
    v_mfma_f32_16x16x32_bf16 v[176:179], a[104:107], v[20:23], v[176:179]
    ds_read_b64_tr_b16 a[192:193], v231 offset:0
    ds_read_b64_tr_b16 a[194:195], v231 offset:4096
    v_mfma_f32_16x16x32_bf16 v[176:179], a[108:111], v[24:27], v[176:179]
    v_exp_f32 v185, v185
    v_mfma_f32_16x16x32_bf16 v[176:179], a[112:115], v[28:31], v[176:179]
    v_cvt_pk_bf16_f32 v196, v184, v185
    v_mfma_f32_16x16x32_bf16 v[180:183], a[116:119], v[16:19], v[200:203]
    v_exp_f32 v186, v186
    v_mfma_f32_16x16x32_bf16 v[180:183], a[120:123], v[20:23], v[180:183]
    buffer_load_dwordx4 v235, s[20:23], 0 offen offset:1024 sc1 nt lds
    v_mfma_f32_16x16x32_bf16 v[180:183], a[124:127], v[24:27], v[180:183]
    v_exp_f32 v187, v187
    v_mfma_f32_16x16x32_bf16 v[180:183], a[128:131], v[28:31], v[180:183]
    v_cvt_pk_bf16_f32 v197, v186, v187
    v_mfma_f32_16x16x32_bf16 v[144:147], a[196:199], v[192:195], v[144:147]
    s_add_u32 m0, s41, 81920
    v_exp_f32 v188, v188
    v_mfma_f32_16x16x32_bf16 v[148:151], a[200:203], v[192:195], v[148:151]
    buffer_load_dwordx4 v234, s[24:27], 0 offen sc1 nt lds
    v_mfma_f32_16x16x32_bf16 v[152:155], a[204:207], v[192:195], v[152:155]
    v_exp_f32 v189, v189
    v_mfma_f32_16x16x32_bf16 v[156:159], a[208:211], v[192:195], v[156:159]
    v_cvt_pk_bf16_f32 v198, v188, v189
    v_mfma_f32_16x16x32_bf16 a[48:51], a[212:215], v[192:195], a[48:51]
    v_exp_f32 v190, v190
    v_mfma_f32_16x16x32_bf16 a[52:55], a[216:219], v[192:195], a[52:55]
    buffer_load_dwordx4 v235, s[24:27], 0 offen offset:1024 sc1 nt lds
    v_mfma_f32_16x16x32_bf16 a[56:59], a[220:223], v[192:195], a[56:59]
    v_exp_f32 v191, v191
    v_mfma_f32_16x16x32_bf16 a[60:63], a[224:227], v[192:195], a[60:63]
    s_waitcnt lgkmcnt(0)
    v_cvt_pk_bf16_f32 v199, v190, v191
    v_mfma_f32_16x16x32_bf16 a[92:95], v[236:239], v[192:195], a[92:95]
    v_mfma_f32_16x16x32_bf16 v[184:187], a[100:103], v[32:35], v[204:207]
    s_waitcnt vmcnt(8)
    s_barrier
    v_exp_f32 v176, v176
    v_mfma_f32_16x16x32_bf16 v[184:187], a[104:107], v[36:39], v[184:187]
    ds_read_b128 a[132:135], v220 offset:8192
    v_add_u32 v234, s45, v234
    v_mfma_f32_16x16x32_bf16 v[184:187], a[108:111], v[40:43], v[184:187]
    v_exp_f32 v177, v177
    v_mfma_f32_16x16x32_bf16 v[184:187], a[112:115], v[44:47], v[184:187]
    v_cvt_pk_bf16_f32 v192, v176, v177
    v_mfma_f32_16x16x32_bf16 v[188:191], a[116:119], v[32:35], v[204:207]
    v_exp_f32 v178, v178
    v_mfma_f32_16x16x32_bf16 v[188:191], a[120:123], v[36:39], v[188:191]
    ds_read_b128 a[136:139], v221 offset:8192
    v_add_u32 v235, s45, v235
    v_mfma_f32_16x16x32_bf16 v[188:191], a[124:127], v[40:43], v[188:191]
    v_exp_f32 v179, v179
    v_mfma_f32_16x16x32_bf16 v[188:191], a[128:131], v[44:47], v[188:191]
    v_cvt_pk_bf16_f32 v193, v178, v179
    v_mfma_f32_16x16x32_bf16 v[160:163], a[196:199], v[196:199], v[160:163]
    v_exp_f32 v180, v180
    v_mfma_f32_16x16x32_bf16 v[164:167], a[200:203], v[196:199], v[164:167]
    ds_read_b128 a[140:143], v222 offset:8192
    v_mfma_f32_16x16x32_bf16 v[168:171], a[204:207], v[196:199], v[168:171]
    v_exp_f32 v181, v181
    v_mfma_f32_16x16x32_bf16 v[172:175], a[208:211], v[196:199], v[172:175]
    v_cvt_pk_bf16_f32 v194, v180, v181
    v_mfma_f32_16x16x32_bf16 a[64:67], a[212:215], v[196:199], a[64:67]
    s_add_u32 m0, s37, 24576
    v_exp_f32 v182, v182
    v_mfma_f32_16x16x32_bf16 a[68:71], a[216:219], v[196:199], a[68:71]
    buffer_load_dwordx4 v232, s[12:15], 0 offen sc1 nt lds
    v_mfma_f32_16x16x32_bf16 a[72:75], a[220:223], v[196:199], a[72:75]
    v_exp_f32 v183, v183
    v_mfma_f32_16x16x32_bf16 a[76:79], a[224:227], v[196:199], a[76:79]
    v_cvt_pk_bf16_f32 v195, v182, v183
    v_mfma_f32_16x16x32_bf16 a[96:99], v[236:239], v[196:199], a[96:99]
    buffer_load_dwordx4 v233, s[12:15], 0 offen offset:1024 sc1 nt lds
    v_mfma_f32_16x16x32_bf16 v[176:179], a[100:103], v[48:51], v[208:211]
    v_exp_f32 v184, v184
    v_mfma_f32_16x16x32_bf16 v[176:179], a[104:107], v[52:55], v[176:179]
    ds_read_b128 a[144:147], v223 offset:8192
    v_mfma_f32_16x16x32_bf16 v[176:179], a[108:111], v[56:59], v[176:179]
    v_exp_f32 v185, v185
    v_mfma_f32_16x16x32_bf16 v[176:179], a[112:115], v[60:63], v[176:179]
    v_cvt_pk_bf16_f32 v196, v184, v185
    v_mfma_f32_16x16x32_bf16 v[180:183], a[116:119], v[48:51], v[208:211]
    v_exp_f32 v186, v186
    v_mfma_f32_16x16x32_bf16 v[180:183], a[120:123], v[52:55], v[180:183]
    ds_read_b128 a[148:151], v220 offset:12288
    v_mfma_f32_16x16x32_bf16 v[180:183], a[124:127], v[56:59], v[180:183]
    v_exp_f32 v187, v187
    v_mfma_f32_16x16x32_bf16 v[180:183], a[128:131], v[60:63], v[180:183]
    v_cvt_pk_bf16_f32 v197, v186, v187
    v_mfma_f32_16x16x32_bf16 v[96:99], a[164:167], v[192:195], v[96:99]
    v_exp_f32 v188, v188
    v_mfma_f32_16x16x32_bf16 v[100:103], a[168:171], v[192:195], v[100:103]
    ds_read_b64_tr_b16 a[196:197], v224 offset:8192
    ds_read_b64_tr_b16 a[198:199], v224 offset:12288
    v_mfma_f32_16x16x32_bf16 v[104:107], a[172:175], v[192:195], v[104:107]
    v_exp_f32 v189, v189
    v_mfma_f32_16x16x32_bf16 v[108:111], a[176:179], v[192:195], v[108:111]
    v_cvt_pk_bf16_f32 v198, v188, v189
    v_mfma_f32_16x16x32_bf16 a[0:3], a[180:183], v[192:195], a[0:3]
    v_exp_f32 v190, v190
    v_mfma_f32_16x16x32_bf16 a[4:7], a[184:187], v[192:195], a[4:7]
    ds_read_b64_tr_b16 a[200:201], v225 offset:8192
    ds_read_b64_tr_b16 a[202:203], v225 offset:12288
    v_mfma_f32_16x16x32_bf16 a[8:11], a[188:191], v[192:195], a[8:11]
    v_exp_f32 v191, v191
    v_mfma_f32_16x16x32_bf16 a[12:15], a[192:195], v[192:195], a[12:15]
    s_add_u32 m0, s37, 90112
    v_cvt_pk_bf16_f32 v199, v190, v191
    v_mfma_f32_16x16x32_bf16 a[80:83], v[236:239], v[192:195], a[80:83]
    buffer_load_dwordx4 v232, s[16:19], 0 offen sc1 nt lds
    v_mfma_f32_16x16x32_bf16 v[184:187], a[100:103], v[64:67], v[212:215]
    v_exp_f32 v176, v176
    v_mfma_f32_16x16x32_bf16 v[184:187], a[104:107], v[68:71], v[184:187]
    ds_read_b128 a[152:155], v221 offset:12288
    v_add_u32 v232, s45, v232
    v_mfma_f32_16x16x32_bf16 v[184:187], a[108:111], v[72:75], v[184:187]
    v_exp_f32 v177, v177
    v_mfma_f32_16x16x32_bf16 v[184:187], a[112:115], v[76:79], v[184:187]
    v_cvt_pk_bf16_f32 v192, v176, v177
    v_mfma_f32_16x16x32_bf16 v[188:191], a[116:119], v[64:67], v[212:215]
    v_exp_f32 v178, v178
    v_mfma_f32_16x16x32_bf16 v[188:191], a[120:123], v[68:71], v[188:191]
    ds_read_b128 a[156:159], v222 offset:12288
    v_mfma_f32_16x16x32_bf16 v[188:191], a[124:127], v[72:75], v[188:191]
    v_exp_f32 v179, v179
    v_mfma_f32_16x16x32_bf16 v[188:191], a[128:131], v[76:79], v[188:191]
    v_cvt_pk_bf16_f32 v193, v178, v179
    v_mfma_f32_16x16x32_bf16 v[112:115], a[164:167], v[196:199], v[112:115]
    v_exp_f32 v180, v180
    v_mfma_f32_16x16x32_bf16 v[116:119], a[168:171], v[196:199], v[116:119]
    ds_read_b64_tr_b16 a[204:205], v226 offset:8192
    ds_read_b64_tr_b16 a[206:207], v226 offset:12288
    v_mfma_f32_16x16x32_bf16 v[120:123], a[172:175], v[196:199], v[120:123]
    v_exp_f32 v181, v181
    v_mfma_f32_16x16x32_bf16 v[124:127], a[176:179], v[196:199], v[124:127]
    v_cvt_pk_bf16_f32 v194, v180, v181
    v_mfma_f32_16x16x32_bf16 a[16:19], a[180:183], v[196:199], a[16:19]
    v_exp_f32 v182, v182
    v_mfma_f32_16x16x32_bf16 a[20:23], a[184:187], v[196:199], a[20:23]
    ds_read_b64_tr_b16 a[208:209], v227 offset:8192
    ds_read_b64_tr_b16 a[210:211], v227 offset:12288
    v_mfma_f32_16x16x32_bf16 a[24:27], a[188:191], v[196:199], a[24:27]
    v_exp_f32 v183, v183
    v_mfma_f32_16x16x32_bf16 a[28:31], a[192:195], v[196:199], a[28:31]
    v_cvt_pk_bf16_f32 v195, v182, v183
    v_mfma_f32_16x16x32_bf16 a[84:87], v[236:239], v[196:199], a[84:87]
    buffer_load_dwordx4 v233, s[16:19], 0 offen offset:1024 sc1 nt lds
    v_mfma_f32_16x16x32_bf16 v[176:179], a[100:103], v[80:83], v[216:219]
    v_exp_f32 v184, v184
    v_mfma_f32_16x16x32_bf16 v[176:179], a[104:107], v[84:87], v[176:179]
    ds_read_b128 a[160:163], v223 offset:12288
    v_add_u32 v233, s45, v233
    v_mfma_f32_16x16x32_bf16 v[176:179], a[108:111], v[88:91], v[176:179]
    v_exp_f32 v185, v185
    v_mfma_f32_16x16x32_bf16 v[176:179], a[112:115], v[92:95], v[176:179]
    v_cvt_pk_bf16_f32 v196, v184, v185
    v_mfma_f32_16x16x32_bf16 v[180:183], a[116:119], v[80:83], v[216:219]
    v_exp_f32 v186, v186
    v_mfma_f32_16x16x32_bf16 v[180:183], a[120:123], v[84:87], v[180:183]
    ds_read_b64_tr_b16 a[212:213], v228 offset:8192
    ds_read_b64_tr_b16 a[214:215], v228 offset:12288
    v_mfma_f32_16x16x32_bf16 v[180:183], a[124:127], v[88:91], v[180:183]
    v_exp_f32 v187, v187
    v_mfma_f32_16x16x32_bf16 v[180:183], a[128:131], v[92:95], v[180:183]
    v_cvt_pk_bf16_f32 v197, v186, v187
    v_mfma_f32_16x16x32_bf16 v[128:131], a[164:167], v[192:195], v[128:131]
    v_exp_f32 v188, v188
    v_mfma_f32_16x16x32_bf16 v[132:135], a[168:171], v[192:195], v[132:135]
    ds_read_b64_tr_b16 a[216:217], v229 offset:8192
    ds_read_b64_tr_b16 a[218:219], v229 offset:12288
    v_mfma_f32_16x16x32_bf16 v[136:139], a[172:175], v[192:195], v[136:139]
    v_exp_f32 v189, v189
    v_mfma_f32_16x16x32_bf16 v[140:143], a[176:179], v[192:195], v[140:143]
    v_cvt_pk_bf16_f32 v198, v188, v189
    v_mfma_f32_16x16x32_bf16 a[32:35], a[180:183], v[192:195], a[32:35]
    v_exp_f32 v190, v190
    v_mfma_f32_16x16x32_bf16 a[36:39], a[184:187], v[192:195], a[36:39]
    ds_read_b64_tr_b16 a[220:221], v230 offset:8192
    ds_read_b64_tr_b16 a[222:223], v230 offset:12288
    v_mfma_f32_16x16x32_bf16 a[40:43], a[188:191], v[192:195], a[40:43]
    v_exp_f32 v191, v191
    v_mfma_f32_16x16x32_bf16 a[44:47], a[192:195], v[192:195], a[44:47]
    s_add_u32 m0, s41, 24576
    v_cvt_pk_bf16_f32 v199, v190, v191
    v_mfma_f32_16x16x32_bf16 a[88:91], v[236:239], v[192:195], a[88:91]
    s_waitcnt lgkmcnt(6)
    buffer_load_dwordx4 v234, s[20:23], 0 offen sc1 nt lds
    v_mfma_f32_16x16x32_bf16 v[184:187], a[132:135], v[16:19], v[200:203]
    v_exp_f32 v176, v176
    v_mfma_f32_16x16x32_bf16 v[184:187], a[136:139], v[20:23], v[184:187]
    ds_read_b64_tr_b16 a[224:225], v231 offset:8192
    ds_read_b64_tr_b16 a[226:227], v231 offset:12288
    v_mfma_f32_16x16x32_bf16 v[184:187], a[140:143], v[24:27], v[184:187]
    v_exp_f32 v177, v177
    v_mfma_f32_16x16x32_bf16 v[184:187], a[144:147], v[28:31], v[184:187]
    v_cvt_pk_bf16_f32 v192, v176, v177
    v_mfma_f32_16x16x32_bf16 v[188:191], a[148:151], v[16:19], v[200:203]
    v_exp_f32 v178, v178
    v_mfma_f32_16x16x32_bf16 v[188:191], a[152:155], v[20:23], v[188:191]
    buffer_load_dwordx4 v235, s[20:23], 0 offen offset:1024 sc1 nt lds
    v_mfma_f32_16x16x32_bf16 v[188:191], a[156:159], v[24:27], v[188:191]
    v_exp_f32 v179, v179
    v_mfma_f32_16x16x32_bf16 v[188:191], a[160:163], v[28:31], v[188:191]
    v_cvt_pk_bf16_f32 v193, v178, v179
    v_mfma_f32_16x16x32_bf16 v[144:147], a[164:167], v[196:199], v[144:147]
    s_add_u32 m0, s41, 90112
    v_exp_f32 v180, v180
    v_mfma_f32_16x16x32_bf16 v[148:151], a[168:171], v[196:199], v[148:151]
    buffer_load_dwordx4 v234, s[24:27], 0 offen sc1 nt lds
    v_mfma_f32_16x16x32_bf16 v[152:155], a[172:175], v[196:199], v[152:155]
    v_exp_f32 v181, v181
    v_mfma_f32_16x16x32_bf16 v[156:159], a[176:179], v[196:199], v[156:159]
    v_cvt_pk_bf16_f32 v194, v180, v181
    v_mfma_f32_16x16x32_bf16 a[48:51], a[180:183], v[196:199], a[48:51]
    v_exp_f32 v182, v182
    v_mfma_f32_16x16x32_bf16 a[52:55], a[184:187], v[196:199], a[52:55]
    buffer_load_dwordx4 v235, s[24:27], 0 offen offset:1024 sc1 nt lds
    v_mfma_f32_16x16x32_bf16 a[56:59], a[188:191], v[196:199], a[56:59]
    v_exp_f32 v183, v183
    v_mfma_f32_16x16x32_bf16 a[60:63], a[192:195], v[196:199], a[60:63]
    s_waitcnt lgkmcnt(0)
    v_cvt_pk_bf16_f32 v195, v182, v183
    v_mfma_f32_16x16x32_bf16 a[92:95], v[236:239], v[196:199], a[92:95]
    v_mfma_f32_16x16x32_bf16 v[176:179], a[132:135], v[32:35], v[204:207]
    s_waitcnt vmcnt(8)
    s_barrier
    v_exp_f32 v184, v184
    v_mfma_f32_16x16x32_bf16 v[176:179], a[136:139], v[36:39], v[176:179]
    ds_read_b128 a[100:103], v220 offset:16384
    v_add_u32 v234, s45, v234
    v_mfma_f32_16x16x32_bf16 v[176:179], a[140:143], v[40:43], v[176:179]
    v_exp_f32 v185, v185
    v_mfma_f32_16x16x32_bf16 v[176:179], a[144:147], v[44:47], v[176:179]
    v_cvt_pk_bf16_f32 v196, v184, v185
    v_mfma_f32_16x16x32_bf16 v[180:183], a[148:151], v[32:35], v[204:207]
    v_exp_f32 v186, v186
    v_mfma_f32_16x16x32_bf16 v[180:183], a[152:155], v[36:39], v[180:183]
    ds_read_b128 a[104:107], v221 offset:16384
    v_add_u32 v235, s45, v235
    v_mfma_f32_16x16x32_bf16 v[180:183], a[156:159], v[40:43], v[180:183]
    v_exp_f32 v187, v187
    v_mfma_f32_16x16x32_bf16 v[180:183], a[160:163], v[44:47], v[180:183]
    v_cvt_pk_bf16_f32 v197, v186, v187
    v_mfma_f32_16x16x32_bf16 v[160:163], a[164:167], v[192:195], v[160:163]
    v_exp_f32 v188, v188
    v_mfma_f32_16x16x32_bf16 v[164:167], a[168:171], v[192:195], v[164:167]
    ds_read_b128 a[108:111], v222 offset:16384
    v_mfma_f32_16x16x32_bf16 v[168:171], a[172:175], v[192:195], v[168:171]
    v_exp_f32 v189, v189
    v_mfma_f32_16x16x32_bf16 v[172:175], a[176:179], v[192:195], v[172:175]
    v_cvt_pk_bf16_f32 v198, v188, v189
    v_mfma_f32_16x16x32_bf16 a[64:67], a[180:183], v[192:195], a[64:67]
    s_add_u32 m0, s37, 0
    v_exp_f32 v190, v190
    v_mfma_f32_16x16x32_bf16 a[68:71], a[184:187], v[192:195], a[68:71]
    buffer_load_dwordx4 v232, s[12:15], 0 offen sc1 nt lds
    v_mfma_f32_16x16x32_bf16 a[72:75], a[188:191], v[192:195], a[72:75]
    v_exp_f32 v191, v191
    v_mfma_f32_16x16x32_bf16 a[76:79], a[192:195], v[192:195], a[76:79]
    v_cvt_pk_bf16_f32 v199, v190, v191
    v_mfma_f32_16x16x32_bf16 a[96:99], v[236:239], v[192:195], a[96:99]
    buffer_load_dwordx4 v233, s[12:15], 0 offen offset:1024 sc1 nt lds
    v_mfma_f32_16x16x32_bf16 v[184:187], a[132:135], v[48:51], v[208:211]
    v_exp_f32 v176, v176
    v_mfma_f32_16x16x32_bf16 v[184:187], a[136:139], v[52:55], v[184:187]
    ds_read_b128 a[112:115], v223 offset:16384
    v_mfma_f32_16x16x32_bf16 v[184:187], a[140:143], v[56:59], v[184:187]
    v_exp_f32 v177, v177
    v_mfma_f32_16x16x32_bf16 v[184:187], a[144:147], v[60:63], v[184:187]
    v_cvt_pk_bf16_f32 v192, v176, v177
    v_mfma_f32_16x16x32_bf16 v[188:191], a[148:151], v[48:51], v[208:211]
    v_exp_f32 v178, v178
    v_mfma_f32_16x16x32_bf16 v[188:191], a[152:155], v[52:55], v[188:191]
    ds_read_b128 a[116:119], v220 offset:20480
    v_mfma_f32_16x16x32_bf16 v[188:191], a[156:159], v[56:59], v[188:191]
    v_exp_f32 v179, v179
    v_mfma_f32_16x16x32_bf16 v[188:191], a[160:163], v[60:63], v[188:191]
    v_cvt_pk_bf16_f32 v193, v178, v179
    v_mfma_f32_16x16x32_bf16 v[96:99], a[196:199], v[196:199], v[96:99]
    v_exp_f32 v180, v180
    v_mfma_f32_16x16x32_bf16 v[100:103], a[200:203], v[196:199], v[100:103]
    ds_read_b64_tr_b16 a[164:165], v224 offset:16384
    ds_read_b64_tr_b16 a[166:167], v224 offset:20480
    v_mfma_f32_16x16x32_bf16 v[104:107], a[204:207], v[196:199], v[104:107]
    v_exp_f32 v181, v181
    v_mfma_f32_16x16x32_bf16 v[108:111], a[208:211], v[196:199], v[108:111]
    v_cvt_pk_bf16_f32 v194, v180, v181
    v_mfma_f32_16x16x32_bf16 a[0:3], a[212:215], v[196:199], a[0:3]
    v_exp_f32 v182, v182
    v_mfma_f32_16x16x32_bf16 a[4:7], a[216:219], v[196:199], a[4:7]
    ds_read_b64_tr_b16 a[168:169], v225 offset:16384
    ds_read_b64_tr_b16 a[170:171], v225 offset:20480
    v_mfma_f32_16x16x32_bf16 a[8:11], a[220:223], v[196:199], a[8:11]
    v_exp_f32 v183, v183
    v_mfma_f32_16x16x32_bf16 a[12:15], a[224:227], v[196:199], a[12:15]
    s_add_u32 m0, s37, 65536
    v_cvt_pk_bf16_f32 v195, v182, v183
    v_mfma_f32_16x16x32_bf16 a[80:83], v[236:239], v[196:199], a[80:83]
    buffer_load_dwordx4 v232, s[16:19], 0 offen sc1 nt lds
    v_mfma_f32_16x16x32_bf16 v[176:179], a[132:135], v[64:67], v[212:215]
    v_exp_f32 v184, v184
    v_mfma_f32_16x16x32_bf16 v[176:179], a[136:139], v[68:71], v[176:179]
    ds_read_b128 a[120:123], v221 offset:20480
    v_add_u32 v232, s45, v232
    v_mfma_f32_16x16x32_bf16 v[176:179], a[140:143], v[72:75], v[176:179]
    v_exp_f32 v185, v185
    v_mfma_f32_16x16x32_bf16 v[176:179], a[144:147], v[76:79], v[176:179]
    v_cvt_pk_bf16_f32 v196, v184, v185
    v_mfma_f32_16x16x32_bf16 v[180:183], a[148:151], v[64:67], v[212:215]
    v_exp_f32 v186, v186
    v_mfma_f32_16x16x32_bf16 v[180:183], a[152:155], v[68:71], v[180:183]
    ds_read_b128 a[124:127], v222 offset:20480
    v_mfma_f32_16x16x32_bf16 v[180:183], a[156:159], v[72:75], v[180:183]
    v_exp_f32 v187, v187
    v_mfma_f32_16x16x32_bf16 v[180:183], a[160:163], v[76:79], v[180:183]
    v_cvt_pk_bf16_f32 v197, v186, v187
    v_mfma_f32_16x16x32_bf16 v[112:115], a[196:199], v[192:195], v[112:115]
    v_exp_f32 v188, v188
    v_mfma_f32_16x16x32_bf16 v[116:119], a[200:203], v[192:195], v[116:119]
    ds_read_b64_tr_b16 a[172:173], v226 offset:16384
    ds_read_b64_tr_b16 a[174:175], v226 offset:20480
    v_mfma_f32_16x16x32_bf16 v[120:123], a[204:207], v[192:195], v[120:123]
    v_exp_f32 v189, v189
    v_mfma_f32_16x16x32_bf16 v[124:127], a[208:211], v[192:195], v[124:127]
    v_cvt_pk_bf16_f32 v198, v188, v189
    v_mfma_f32_16x16x32_bf16 a[16:19], a[212:215], v[192:195], a[16:19]
    v_exp_f32 v190, v190
    v_mfma_f32_16x16x32_bf16 a[20:23], a[216:219], v[192:195], a[20:23]
    ds_read_b64_tr_b16 a[176:177], v227 offset:16384
    ds_read_b64_tr_b16 a[178:179], v227 offset:20480
    v_mfma_f32_16x16x32_bf16 a[24:27], a[220:223], v[192:195], a[24:27]
    v_exp_f32 v191, v191
    v_mfma_f32_16x16x32_bf16 a[28:31], a[224:227], v[192:195], a[28:31]
    v_cvt_pk_bf16_f32 v199, v190, v191
    v_mfma_f32_16x16x32_bf16 a[84:87], v[236:239], v[192:195], a[84:87]
    buffer_load_dwordx4 v233, s[16:19], 0 offen offset:1024 sc1 nt lds
    v_mfma_f32_16x16x32_bf16 v[184:187], a[132:135], v[80:83], v[216:219]
    v_exp_f32 v176, v176
    v_mfma_f32_16x16x32_bf16 v[184:187], a[136:139], v[84:87], v[184:187]
    ds_read_b128 a[128:131], v223 offset:20480
    v_add_u32 v233, s45, v233
    v_mfma_f32_16x16x32_bf16 v[184:187], a[140:143], v[88:91], v[184:187]
    v_exp_f32 v177, v177
    v_mfma_f32_16x16x32_bf16 v[184:187], a[144:147], v[92:95], v[184:187]
    v_cvt_pk_bf16_f32 v192, v176, v177
    v_mfma_f32_16x16x32_bf16 v[188:191], a[148:151], v[80:83], v[216:219]
    v_exp_f32 v178, v178
    v_mfma_f32_16x16x32_bf16 v[188:191], a[152:155], v[84:87], v[188:191]
    ds_read_b64_tr_b16 a[180:181], v228 offset:16384
    ds_read_b64_tr_b16 a[182:183], v228 offset:20480
    v_mfma_f32_16x16x32_bf16 v[188:191], a[156:159], v[88:91], v[188:191]
    v_exp_f32 v179, v179
    v_mfma_f32_16x16x32_bf16 v[188:191], a[160:163], v[92:95], v[188:191]
    v_cvt_pk_bf16_f32 v193, v178, v179
    v_mfma_f32_16x16x32_bf16 v[128:131], a[196:199], v[196:199], v[128:131]
    v_exp_f32 v180, v180
    v_mfma_f32_16x16x32_bf16 v[132:135], a[200:203], v[196:199], v[132:135]
    ds_read_b64_tr_b16 a[184:185], v229 offset:16384
    ds_read_b64_tr_b16 a[186:187], v229 offset:20480
    v_mfma_f32_16x16x32_bf16 v[136:139], a[204:207], v[196:199], v[136:139]
    v_exp_f32 v181, v181
    v_mfma_f32_16x16x32_bf16 v[140:143], a[208:211], v[196:199], v[140:143]
    v_cvt_pk_bf16_f32 v194, v180, v181
    v_mfma_f32_16x16x32_bf16 a[32:35], a[212:215], v[196:199], a[32:35]
    v_exp_f32 v182, v182
    v_mfma_f32_16x16x32_bf16 a[36:39], a[216:219], v[196:199], a[36:39]
    ds_read_b64_tr_b16 a[188:189], v230 offset:16384
    ds_read_b64_tr_b16 a[190:191], v230 offset:20480
    v_mfma_f32_16x16x32_bf16 a[40:43], a[220:223], v[196:199], a[40:43]
    v_exp_f32 v183, v183
    v_mfma_f32_16x16x32_bf16 a[44:47], a[224:227], v[196:199], a[44:47]
    s_add_u32 m0, s41, 0
    v_cvt_pk_bf16_f32 v195, v182, v183
    v_mfma_f32_16x16x32_bf16 a[88:91], v[236:239], v[196:199], a[88:91]
    s_waitcnt lgkmcnt(6)
    buffer_load_dwordx4 v234, s[20:23], 0 offen sc1 nt lds
    v_mfma_f32_16x16x32_bf16 v[176:179], a[100:103], v[16:19], v[200:203]
    v_exp_f32 v184, v184
    v_mfma_f32_16x16x32_bf16 v[176:179], a[104:107], v[20:23], v[176:179]
    ds_read_b64_tr_b16 a[192:193], v231 offset:16384
    ds_read_b64_tr_b16 a[194:195], v231 offset:20480
    v_mfma_f32_16x16x32_bf16 v[176:179], a[108:111], v[24:27], v[176:179]
    v_exp_f32 v185, v185
    v_mfma_f32_16x16x32_bf16 v[176:179], a[112:115], v[28:31], v[176:179]
    v_cvt_pk_bf16_f32 v196, v184, v185
    v_mfma_f32_16x16x32_bf16 v[180:183], a[116:119], v[16:19], v[200:203]
    v_exp_f32 v186, v186
    v_mfma_f32_16x16x32_bf16 v[180:183], a[120:123], v[20:23], v[180:183]
    buffer_load_dwordx4 v235, s[20:23], 0 offen offset:1024 sc1 nt lds
    v_mfma_f32_16x16x32_bf16 v[180:183], a[124:127], v[24:27], v[180:183]
    v_exp_f32 v187, v187
    v_mfma_f32_16x16x32_bf16 v[180:183], a[128:131], v[28:31], v[180:183]
    v_cvt_pk_bf16_f32 v197, v186, v187
    v_mfma_f32_16x16x32_bf16 v[144:147], a[196:199], v[192:195], v[144:147]
    s_add_u32 m0, s41, 65536
    v_exp_f32 v188, v188
    v_mfma_f32_16x16x32_bf16 v[148:151], a[200:203], v[192:195], v[148:151]
    buffer_load_dwordx4 v234, s[24:27], 0 offen sc1 nt lds
    v_mfma_f32_16x16x32_bf16 v[152:155], a[204:207], v[192:195], v[152:155]
    v_exp_f32 v189, v189
    v_mfma_f32_16x16x32_bf16 v[156:159], a[208:211], v[192:195], v[156:159]
    v_cvt_pk_bf16_f32 v198, v188, v189
    v_mfma_f32_16x16x32_bf16 a[48:51], a[212:215], v[192:195], a[48:51]
    v_exp_f32 v190, v190
    v_mfma_f32_16x16x32_bf16 a[52:55], a[216:219], v[192:195], a[52:55]
    buffer_load_dwordx4 v235, s[24:27], 0 offen offset:1024 sc1 nt lds
    v_mfma_f32_16x16x32_bf16 a[56:59], a[220:223], v[192:195], a[56:59]
    v_exp_f32 v191, v191
    v_mfma_f32_16x16x32_bf16 a[60:63], a[224:227], v[192:195], a[60:63]
    s_waitcnt lgkmcnt(0)
    s_sub_u32 s40, s40, 1
    v_cvt_pk_bf16_f32 v199, v190, v191
    v_mfma_f32_16x16x32_bf16 a[92:95], v[236:239], v[192:195], a[92:95]
    s_cmp_lg_u32 s40, 0
    s_cbranch_scc1 L_loop
    v_mfma_f32_16x16x32_bf16 v[184:187], a[100:103], v[32:35], v[204:207]
    s_waitcnt vmcnt(8)
    s_barrier
    v_exp_f32 v176, v176
    v_mfma_f32_16x16x32_bf16 v[184:187], a[104:107], v[36:39], v[184:187]
    ds_read_b128 a[132:135], v220 offset:24576
    v_mfma_f32_16x16x32_bf16 v[184:187], a[108:111], v[40:43], v[184:187]
    v_exp_f32 v177, v177
    v_mfma_f32_16x16x32_bf16 v[184:187], a[112:115], v[44:47], v[184:187]
    v_cvt_pk_bf16_f32 v192, v176, v177
    v_mfma_f32_16x16x32_bf16 v[188:191], a[116:119], v[32:35], v[204:207]
    v_exp_f32 v178, v178
    v_mfma_f32_16x16x32_bf16 v[188:191], a[120:123], v[36:39], v[188:191]
    ds_read_b128 a[136:139], v221 offset:24576
    v_mfma_f32_16x16x32_bf16 v[188:191], a[124:127], v[40:43], v[188:191]
    v_exp_f32 v179, v179
    v_mfma_f32_16x16x32_bf16 v[188:191], a[128:131], v[44:47], v[188:191]
    v_cvt_pk_bf16_f32 v193, v178, v179
    v_mfma_f32_16x16x32_bf16 v[160:163], a[196:199], v[196:199], v[160:163]
    v_exp_f32 v180, v180
    v_mfma_f32_16x16x32_bf16 v[164:167], a[200:203], v[196:199], v[164:167]
    ds_read_b128 a[140:143], v222 offset:24576
    v_mfma_f32_16x16x32_bf16 v[168:171], a[204:207], v[196:199], v[168:171]
    v_exp_f32 v181, v181
    v_mfma_f32_16x16x32_bf16 v[172:175], a[208:211], v[196:199], v[172:175]
    v_cvt_pk_bf16_f32 v194, v180, v181
    v_mfma_f32_16x16x32_bf16 a[64:67], a[212:215], v[196:199], a[64:67]
    v_exp_f32 v182, v182
    v_mfma_f32_16x16x32_bf16 a[68:71], a[216:219], v[196:199], a[68:71]
    v_mfma_f32_16x16x32_bf16 a[72:75], a[220:223], v[196:199], a[72:75]
    v_exp_f32 v183, v183
    v_mfma_f32_16x16x32_bf16 a[76:79], a[224:227], v[196:199], a[76:79]
    v_cvt_pk_bf16_f32 v195, v182, v183
    v_mfma_f32_16x16x32_bf16 a[96:99], v[236:239], v[196:199], a[96:99]
    v_mfma_f32_16x16x32_bf16 v[176:179], a[100:103], v[48:51], v[208:211]
    v_exp_f32 v184, v184
    v_mfma_f32_16x16x32_bf16 v[176:179], a[104:107], v[52:55], v[176:179]
    ds_read_b128 a[144:147], v223 offset:24576
    v_mfma_f32_16x16x32_bf16 v[176:179], a[108:111], v[56:59], v[176:179]
    v_exp_f32 v185, v185
    v_mfma_f32_16x16x32_bf16 v[176:179], a[112:115], v[60:63], v[176:179]
    v_cvt_pk_bf16_f32 v196, v184, v185
    v_mfma_f32_16x16x32_bf16 v[180:183], a[116:119], v[48:51], v[208:211]
    v_exp_f32 v186, v186
    v_mfma_f32_16x16x32_bf16 v[180:183], a[120:123], v[52:55], v[180:183]
    ds_read_b128 a[148:151], v220 offset:28672
    v_mfma_f32_16x16x32_bf16 v[180:183], a[124:127], v[56:59], v[180:183]
    v_exp_f32 v187, v187
    v_mfma_f32_16x16x32_bf16 v[180:183], a[128:131], v[60:63], v[180:183]
    v_cvt_pk_bf16_f32 v197, v186, v187
    v_mfma_f32_16x16x32_bf16 v[96:99], a[164:167], v[192:195], v[96:99]
    v_exp_f32 v188, v188
    v_mfma_f32_16x16x32_bf16 v[100:103], a[168:171], v[192:195], v[100:103]
    ds_read_b64_tr_b16 a[196:197], v224 offset:24576
    ds_read_b64_tr_b16 a[198:199], v224 offset:28672
    v_mfma_f32_16x16x32_bf16 v[104:107], a[172:175], v[192:195], v[104:107]
    v_exp_f32 v189, v189
    v_mfma_f32_16x16x32_bf16 v[108:111], a[176:179], v[192:195], v[108:111]
    v_cvt_pk_bf16_f32 v198, v188, v189
    v_mfma_f32_16x16x32_bf16 a[0:3], a[180:183], v[192:195], a[0:3]
    v_exp_f32 v190, v190
    v_mfma_f32_16x16x32_bf16 a[4:7], a[184:187], v[192:195], a[4:7]
    ds_read_b64_tr_b16 a[200:201], v225 offset:24576
    ds_read_b64_tr_b16 a[202:203], v225 offset:28672
    v_mfma_f32_16x16x32_bf16 a[8:11], a[188:191], v[192:195], a[8:11]
    v_exp_f32 v191, v191
    v_mfma_f32_16x16x32_bf16 a[12:15], a[192:195], v[192:195], a[12:15]
    v_cvt_pk_bf16_f32 v199, v190, v191
    v_mfma_f32_16x16x32_bf16 a[80:83], v[236:239], v[192:195], a[80:83]
    v_mfma_f32_16x16x32_bf16 v[184:187], a[100:103], v[64:67], v[212:215]
    v_exp_f32 v176, v176
    v_mfma_f32_16x16x32_bf16 v[184:187], a[104:107], v[68:71], v[184:187]
    ds_read_b128 a[152:155], v221 offset:28672
    v_mfma_f32_16x16x32_bf16 v[184:187], a[108:111], v[72:75], v[184:187]
    v_exp_f32 v177, v177
    v_mfma_f32_16x16x32_bf16 v[184:187], a[112:115], v[76:79], v[184:187]
    v_cvt_pk_bf16_f32 v192, v176, v177
    v_mfma_f32_16x16x32_bf16 v[188:191], a[116:119], v[64:67], v[212:215]
    v_exp_f32 v178, v178
    v_mfma_f32_16x16x32_bf16 v[188:191], a[120:123], v[68:71], v[188:191]
    ds_read_b128 a[156:159], v222 offset:28672
    v_mfma_f32_16x16x32_bf16 v[188:191], a[124:127], v[72:75], v[188:191]
    v_exp_f32 v179, v179
    v_mfma_f32_16x16x32_bf16 v[188:191], a[128:131], v[76:79], v[188:191]
    v_cvt_pk_bf16_f32 v193, v178, v179
    v_mfma_f32_16x16x32_bf16 v[112:115], a[164:167], v[196:199], v[112:115]
    v_exp_f32 v180, v180
    v_mfma_f32_16x16x32_bf16 v[116:119], a[168:171], v[196:199], v[116:119]
    ds_read_b64_tr_b16 a[204:205], v226 offset:24576
    ds_read_b64_tr_b16 a[206:207], v226 offset:28672
    v_mfma_f32_16x16x32_bf16 v[120:123], a[172:175], v[196:199], v[120:123]
    v_exp_f32 v181, v181
    v_mfma_f32_16x16x32_bf16 v[124:127], a[176:179], v[196:199], v[124:127]
    v_cvt_pk_bf16_f32 v194, v180, v181
    v_mfma_f32_16x16x32_bf16 a[16:19], a[180:183], v[196:199], a[16:19]
    v_exp_f32 v182, v182
    v_mfma_f32_16x16x32_bf16 a[20:23], a[184:187], v[196:199], a[20:23]
    ds_read_b64_tr_b16 a[208:209], v227 offset:24576
    ds_read_b64_tr_b16 a[210:211], v227 offset:28672
    v_mfma_f32_16x16x32_bf16 a[24:27], a[188:191], v[196:199], a[24:27]
    v_exp_f32 v183, v183
    v_mfma_f32_16x16x32_bf16 a[28:31], a[192:195], v[196:199], a[28:31]
    v_cvt_pk_bf16_f32 v195, v182, v183
    v_mfma_f32_16x16x32_bf16 a[84:87], v[236:239], v[196:199], a[84:87]
    v_mfma_f32_16x16x32_bf16 v[176:179], a[100:103], v[80:83], v[216:219]
    v_exp_f32 v184, v184
    v_mfma_f32_16x16x32_bf16 v[176:179], a[104:107], v[84:87], v[176:179]
    ds_read_b128 a[160:163], v223 offset:28672
    v_mfma_f32_16x16x32_bf16 v[176:179], a[108:111], v[88:91], v[176:179]
    v_exp_f32 v185, v185
    v_mfma_f32_16x16x32_bf16 v[176:179], a[112:115], v[92:95], v[176:179]
    v_cvt_pk_bf16_f32 v196, v184, v185
    v_mfma_f32_16x16x32_bf16 v[180:183], a[116:119], v[80:83], v[216:219]
    v_exp_f32 v186, v186
    v_mfma_f32_16x16x32_bf16 v[180:183], a[120:123], v[84:87], v[180:183]
    ds_read_b64_tr_b16 a[212:213], v228 offset:24576
    ds_read_b64_tr_b16 a[214:215], v228 offset:28672
    v_mfma_f32_16x16x32_bf16 v[180:183], a[124:127], v[88:91], v[180:183]
    v_exp_f32 v187, v187
    v_mfma_f32_16x16x32_bf16 v[180:183], a[128:131], v[92:95], v[180:183]
    v_cvt_pk_bf16_f32 v197, v186, v187
    v_mfma_f32_16x16x32_bf16 v[128:131], a[164:167], v[192:195], v[128:131]
    v_exp_f32 v188, v188
    v_mfma_f32_16x16x32_bf16 v[132:135], a[168:171], v[192:195], v[132:135]
    ds_read_b64_tr_b16 a[216:217], v229 offset:24576
    ds_read_b64_tr_b16 a[218:219], v229 offset:28672
    v_mfma_f32_16x16x32_bf16 v[136:139], a[172:175], v[192:195], v[136:139]
    v_exp_f32 v189, v189
    v_mfma_f32_16x16x32_bf16 v[140:143], a[176:179], v[192:195], v[140:143]
    v_cvt_pk_bf16_f32 v198, v188, v189
    v_mfma_f32_16x16x32_bf16 a[32:35], a[180:183], v[192:195], a[32:35]
    v_exp_f32 v190, v190
    v_mfma_f32_16x16x32_bf16 a[36:39], a[184:187], v[192:195], a[36:39]
    ds_read_b64_tr_b16 a[220:221], v230 offset:24576
    ds_read_b64_tr_b16 a[222:223], v230 offset:28672
    v_mfma_f32_16x16x32_bf16 a[40:43], a[188:191], v[192:195], a[40:43]
    v_exp_f32 v191, v191
    v_mfma_f32_16x16x32_bf16 a[44:47], a[192:195], v[192:195], a[44:47]
    v_cvt_pk_bf16_f32 v199, v190, v191
    v_mfma_f32_16x16x32_bf16 a[88:91], v[236:239], v[192:195], a[88:91]
    s_waitcnt lgkmcnt(6)
    v_mfma_f32_16x16x32_bf16 v[184:187], a[132:135], v[16:19], v[200:203]
    v_exp_f32 v176, v176
    v_mfma_f32_16x16x32_bf16 v[184:187], a[136:139], v[20:23], v[184:187]
    ds_read_b64_tr_b16 a[224:225], v231 offset:24576
    ds_read_b64_tr_b16 a[226:227], v231 offset:28672
    v_mfma_f32_16x16x32_bf16 v[184:187], a[140:143], v[24:27], v[184:187]
    v_exp_f32 v177, v177
    v_mfma_f32_16x16x32_bf16 v[184:187], a[144:147], v[28:31], v[184:187]
    v_cvt_pk_bf16_f32 v192, v176, v177
    v_mfma_f32_16x16x32_bf16 v[188:191], a[148:151], v[16:19], v[200:203]
    v_exp_f32 v178, v178
    v_mfma_f32_16x16x32_bf16 v[188:191], a[152:155], v[20:23], v[188:191]
    v_mfma_f32_16x16x32_bf16 v[188:191], a[156:159], v[24:27], v[188:191]
    v_exp_f32 v179, v179
    v_mfma_f32_16x16x32_bf16 v[188:191], a[160:163], v[28:31], v[188:191]
    v_cvt_pk_bf16_f32 v193, v178, v179
    v_mfma_f32_16x16x32_bf16 v[144:147], a[164:167], v[196:199], v[144:147]
    v_exp_f32 v180, v180
    v_mfma_f32_16x16x32_bf16 v[148:151], a[168:171], v[196:199], v[148:151]
    v_mfma_f32_16x16x32_bf16 v[152:155], a[172:175], v[196:199], v[152:155]
    v_exp_f32 v181, v181
    v_mfma_f32_16x16x32_bf16 v[156:159], a[176:179], v[196:199], v[156:159]
    v_cvt_pk_bf16_f32 v194, v180, v181
    v_mfma_f32_16x16x32_bf16 a[48:51], a[180:183], v[196:199], a[48:51]
    v_exp_f32 v182, v182
    v_mfma_f32_16x16x32_bf16 a[52:55], a[184:187], v[196:199], a[52:55]
    v_mfma_f32_16x16x32_bf16 a[56:59], a[188:191], v[196:199], a[56:59]
    v_exp_f32 v183, v183
    v_mfma_f32_16x16x32_bf16 a[60:63], a[192:195], v[196:199], a[60:63]
    s_waitcnt lgkmcnt(0)
    v_cvt_pk_bf16_f32 v195, v182, v183
    v_mfma_f32_16x16x32_bf16 a[92:95], v[236:239], v[196:199], a[92:95]
    v_mfma_f32_16x16x32_bf16 v[176:179], a[132:135], v[32:35], v[204:207]
    s_waitcnt vmcnt(0)
    s_barrier
    v_exp_f32 v184, v184
    v_mfma_f32_16x16x32_bf16 v[176:179], a[136:139], v[36:39], v[176:179]
    v_mfma_f32_16x16x32_bf16 v[176:179], a[140:143], v[40:43], v[176:179]
    v_exp_f32 v185, v185
    v_mfma_f32_16x16x32_bf16 v[176:179], a[144:147], v[44:47], v[176:179]
    v_cvt_pk_bf16_f32 v196, v184, v185
    v_mfma_f32_16x16x32_bf16 v[180:183], a[148:151], v[32:35], v[204:207]
    v_exp_f32 v186, v186
    v_mfma_f32_16x16x32_bf16 v[180:183], a[152:155], v[36:39], v[180:183]
    v_mfma_f32_16x16x32_bf16 v[180:183], a[156:159], v[40:43], v[180:183]
    v_exp_f32 v187, v187
    v_mfma_f32_16x16x32_bf16 v[180:183], a[160:163], v[44:47], v[180:183]
    v_cvt_pk_bf16_f32 v197, v186, v187
    v_mfma_f32_16x16x32_bf16 v[160:163], a[164:167], v[192:195], v[160:163]
    v_exp_f32 v188, v188
    v_mfma_f32_16x16x32_bf16 v[164:167], a[168:171], v[192:195], v[164:167]
    v_mfma_f32_16x16x32_bf16 v[168:171], a[172:175], v[192:195], v[168:171]
    v_exp_f32 v189, v189
    v_mfma_f32_16x16x32_bf16 v[172:175], a[176:179], v[192:195], v[172:175]
    v_cvt_pk_bf16_f32 v198, v188, v189
    v_mfma_f32_16x16x32_bf16 a[64:67], a[180:183], v[192:195], a[64:67]
    v_exp_f32 v190, v190
    v_mfma_f32_16x16x32_bf16 a[68:71], a[184:187], v[192:195], a[68:71]
    v_mfma_f32_16x16x32_bf16 a[72:75], a[188:191], v[192:195], a[72:75]
    v_exp_f32 v191, v191
    v_mfma_f32_16x16x32_bf16 a[76:79], a[192:195], v[192:195], a[76:79]
    v_cvt_pk_bf16_f32 v199, v190, v191
    v_mfma_f32_16x16x32_bf16 a[96:99], v[236:239], v[192:195], a[96:99]
    v_mfma_f32_16x16x32_bf16 v[184:187], a[132:135], v[48:51], v[208:211]
    v_exp_f32 v176, v176
    v_mfma_f32_16x16x32_bf16 v[184:187], a[136:139], v[52:55], v[184:187]
    v_mfma_f32_16x16x32_bf16 v[184:187], a[140:143], v[56:59], v[184:187]
    v_exp_f32 v177, v177
    v_mfma_f32_16x16x32_bf16 v[184:187], a[144:147], v[60:63], v[184:187]
    v_cvt_pk_bf16_f32 v192, v176, v177
    v_mfma_f32_16x16x32_bf16 v[188:191], a[148:151], v[48:51], v[208:211]
    v_exp_f32 v178, v178
    v_mfma_f32_16x16x32_bf16 v[188:191], a[152:155], v[52:55], v[188:191]
    v_mfma_f32_16x16x32_bf16 v[188:191], a[156:159], v[56:59], v[188:191]
    v_exp_f32 v179, v179
    v_mfma_f32_16x16x32_bf16 v[188:191], a[160:163], v[60:63], v[188:191]
    v_cvt_pk_bf16_f32 v193, v178, v179
    v_mfma_f32_16x16x32_bf16 v[96:99], a[196:199], v[196:199], v[96:99]
    v_exp_f32 v180, v180
    v_mfma_f32_16x16x32_bf16 v[100:103], a[200:203], v[196:199], v[100:103]
    v_mfma_f32_16x16x32_bf16 v[104:107], a[204:207], v[196:199], v[104:107]
    v_exp_f32 v181, v181
    v_mfma_f32_16x16x32_bf16 v[108:111], a[208:211], v[196:199], v[108:111]
    v_cvt_pk_bf16_f32 v194, v180, v181
    v_mfma_f32_16x16x32_bf16 a[0:3], a[212:215], v[196:199], a[0:3]
    v_exp_f32 v182, v182
    v_mfma_f32_16x16x32_bf16 a[4:7], a[216:219], v[196:199], a[4:7]
    v_mfma_f32_16x16x32_bf16 a[8:11], a[220:223], v[196:199], a[8:11]
    v_exp_f32 v183, v183
    v_mfma_f32_16x16x32_bf16 a[12:15], a[224:227], v[196:199], a[12:15]
    v_cvt_pk_bf16_f32 v195, v182, v183
    v_mfma_f32_16x16x32_bf16 a[80:83], v[236:239], v[196:199], a[80:83]
    v_mfma_f32_16x16x32_bf16 v[176:179], a[132:135], v[64:67], v[212:215]
    v_exp_f32 v184, v184
    v_mfma_f32_16x16x32_bf16 v[176:179], a[136:139], v[68:71], v[176:179]
    ds_write_b128 v5, a[0:3] offset:0
    v_mfma_f32_16x16x32_bf16 v[176:179], a[140:143], v[72:75], v[176:179]
    v_exp_f32 v185, v185
    v_mfma_f32_16x16x32_bf16 v[176:179], a[144:147], v[76:79], v[176:179]
    v_cvt_pk_bf16_f32 v196, v184, v185
    v_mfma_f32_16x16x32_bf16 v[180:183], a[148:151], v[64:67], v[212:215]
    v_exp_f32 v186, v186
    v_mfma_f32_16x16x32_bf16 v[180:183], a[152:155], v[68:71], v[180:183]
    ds_write_b128 v5, a[4:7] offset:1024
    v_mfma_f32_16x16x32_bf16 v[180:183], a[156:159], v[72:75], v[180:183]
    v_exp_f32 v187, v187
    v_mfma_f32_16x16x32_bf16 v[180:183], a[160:163], v[76:79], v[180:183]
    v_cvt_pk_bf16_f32 v197, v186, v187
    v_mfma_f32_16x16x32_bf16 v[112:115], a[196:199], v[192:195], v[112:115]
    v_exp_f32 v188, v188
    v_mfma_f32_16x16x32_bf16 v[116:119], a[200:203], v[192:195], v[116:119]
    ds_write_b128 v5, a[8:11] offset:2048
    v_mfma_f32_16x16x32_bf16 v[120:123], a[204:207], v[192:195], v[120:123]
    v_exp_f32 v189, v189
    v_mfma_f32_16x16x32_bf16 v[124:127], a[208:211], v[192:195], v[124:127]
    v_cvt_pk_bf16_f32 v198, v188, v189
    v_mfma_f32_16x16x32_bf16 a[16:19], a[212:215], v[192:195], a[16:19]
    v_exp_f32 v190, v190
    v_mfma_f32_16x16x32_bf16 a[20:23], a[216:219], v[192:195], a[20:23]
    ds_write_b128 v5, a[12:15] offset:3072
    v_mfma_f32_16x16x32_bf16 a[24:27], a[220:223], v[192:195], a[24:27]
    v_exp_f32 v191, v191
    v_mfma_f32_16x16x32_bf16 a[28:31], a[224:227], v[192:195], a[28:31]
    v_cvt_pk_bf16_f32 v199, v190, v191
    v_mfma_f32_16x16x32_bf16 a[84:87], v[236:239], v[192:195], a[84:87]
    v_mfma_f32_16x16x32_bf16 v[184:187], a[132:135], v[80:83], v[216:219]
    v_exp_f32 v176, v176
    v_mfma_f32_16x16x32_bf16 v[184:187], a[136:139], v[84:87], v[184:187]
    ds_write_b128 v5, a[16:19] offset:4096
    v_mfma_f32_16x16x32_bf16 v[184:187], a[140:143], v[88:91], v[184:187]
    v_exp_f32 v177, v177
    v_mfma_f32_16x16x32_bf16 v[184:187], a[144:147], v[92:95], v[184:187]
    v_cvt_pk_bf16_f32 v192, v176, v177
    v_mfma_f32_16x16x32_bf16 v[188:191], a[148:151], v[80:83], v[216:219]
    v_exp_f32 v178, v178
    v_mfma_f32_16x16x32_bf16 v[188:191], a[152:155], v[84:87], v[188:191]
    ds_write_b128 v5, a[20:23] offset:5120
    v_mfma_f32_16x16x32_bf16 v[188:191], a[156:159], v[88:91], v[188:191]
    v_exp_f32 v179, v179
    v_mfma_f32_16x16x32_bf16 v[188:191], a[160:163], v[92:95], v[188:191]
    v_cvt_pk_bf16_f32 v193, v178, v179
    v_mfma_f32_16x16x32_bf16 v[128:131], a[196:199], v[196:199], v[128:131]
    v_exp_f32 v180, v180
    v_mfma_f32_16x16x32_bf16 v[132:135], a[200:203], v[196:199], v[132:135]
    ds_write_b128 v5, a[24:27] offset:6144
    v_mfma_f32_16x16x32_bf16 v[136:139], a[204:207], v[196:199], v[136:139]
    v_exp_f32 v181, v181
    v_mfma_f32_16x16x32_bf16 v[140:143], a[208:211], v[196:199], v[140:143]
    v_cvt_pk_bf16_f32 v194, v180, v181
    v_mfma_f32_16x16x32_bf16 a[32:35], a[212:215], v[196:199], a[32:35]
    v_exp_f32 v182, v182
    v_mfma_f32_16x16x32_bf16 a[36:39], a[216:219], v[196:199], a[36:39]
    ds_write_b128 v5, a[28:31] offset:7168
    v_mfma_f32_16x16x32_bf16 a[40:43], a[220:223], v[196:199], a[40:43]
    v_exp_f32 v183, v183
    v_mfma_f32_16x16x32_bf16 a[44:47], a[224:227], v[196:199], a[44:47]
    v_cvt_pk_bf16_f32 v195, v182, v183
    v_mfma_f32_16x16x32_bf16 a[88:91], v[236:239], v[196:199], a[88:91]
    s_nop 1
    v_mfma_f32_16x16x32_bf16 v[144:147], a[196:199], v[192:195], v[144:147]
    ds_write_b128 v5, a[32:35] offset:8192
    v_exp_f32 v184, v184
    v_exp_f32 v185, v185
    v_mfma_f32_16x16x32_bf16 v[148:151], a[200:203], v[192:195], v[148:151]
    v_exp_f32 v186, v186
    v_mfma_f32_16x16x32_bf16 v[152:155], a[204:207], v[192:195], v[152:155]
    ds_write_b128 v5, a[36:39] offset:9216
    v_exp_f32 v187, v187
    v_mfma_f32_16x16x32_bf16 v[156:159], a[208:211], v[192:195], v[156:159]
    v_exp_f32 v188, v188
    v_exp_f32 v189, v189
    v_mfma_f32_16x16x32_bf16 a[48:51], a[212:215], v[192:195], a[48:51]
    ds_write_b128 v5, a[40:43] offset:10240
    v_exp_f32 v190, v190
    v_mfma_f32_16x16x32_bf16 a[52:55], a[216:219], v[192:195], a[52:55]
    v_exp_f32 v191, v191
    v_mfma_f32_16x16x32_bf16 a[56:59], a[220:223], v[192:195], a[56:59]
    ds_write_b128 v5, a[44:47] offset:11264
    v_cvt_pk_bf16_f32 v196, v184, v185
    v_cvt_pk_bf16_f32 v197, v186, v187
    v_mfma_f32_16x16x32_bf16 a[60:63], a[224:227], v[192:195], a[60:63]
    v_cvt_pk_bf16_f32 v198, v188, v189
    v_mfma_f32_16x16x32_bf16 a[92:95], v[236:239], v[192:195], a[92:95]
    v_cvt_pk_bf16_f32 v199, v190, v191
    s_nop 1
    v_mfma_f32_16x16x32_bf16 a[96:99], v[236:239], v[196:199], a[96:99]
    s_mov_b64 s[50:51], 0
    ds_write_b128 v5, a[48:51] offset:12288
    v_accvgpr_read_b32 v177, a80
    v_mov_b32 v176, v200
    v_cmp_ngt_f32 vcc, s54, v177
    ds_write_b64 v7, v[176:177] offset:0
    s_or_b64 s[50:51], s[50:51], vcc
    v_mfma_f32_16x16x32_bf16 a[64:67], a[212:215], v[196:199], a[64:67]
    ds_write_b128 v5, a[52:55] offset:13312
    v_accvgpr_read_b32 v179, a84
    v_mov_b32 v178, v204
    v_cmp_ngt_f32 vcc, s54, v179
    ds_write_b64 v7, v[178:179] offset:128
    s_or_b64 s[50:51], s[50:51], vcc
    v_mfma_f32_16x16x32_bf16 a[68:71], a[216:219], v[196:199], a[68:71]
    ds_write_b128 v5, a[56:59] offset:14336
    v_accvgpr_read_b32 v181, a88
    v_mov_b32 v180, v208
    v_cmp_ngt_f32 vcc, s54, v181
    ds_write_b64 v7, v[180:181] offset:256
    s_or_b64 s[50:51], s[50:51], vcc
    v_mfma_f32_16x16x32_bf16 a[72:75], a[220:223], v[196:199], a[72:75]
    ds_write_b128 v5, a[60:63] offset:15360
    v_accvgpr_read_b32 v183, a92
    v_mov_b32 v182, v212
    v_cmp_ngt_f32 vcc, s54, v183
    ds_write_b64 v7, v[182:183] offset:384
    s_or_b64 s[50:51], s[50:51], vcc
    v_mfma_f32_16x16x32_bf16 a[76:79], a[224:227], v[196:199], a[76:79]
    v_mfma_f32_16x16x32_bf16 v[160:163], a[196:199], v[196:199], v[160:163]
    v_mfma_f32_16x16x32_bf16 v[164:167], a[200:203], v[196:199], v[164:167]
    v_accvgpr_read_b32 v185, a96
    v_mov_b32 v184, v216
    v_cmp_ngt_f32 vcc, s54, v185
    ds_write_b64 v7, v[184:185] offset:512
    s_or_b64 s[50:51], s[50:51], vcc
    v_mfma_f32_16x16x32_bf16 v[168:171], a[204:207], v[196:199], v[168:171]
    v_mfma_f32_16x16x32_bf16 v[172:175], a[208:211], v[196:199], v[172:175]
    s_or_b32 s50, s50, s51
    s_cmp_lg_u32 s50, 0
    s_cselect_b32 s50, 1, 0
    s_lshl_b32 s49, s36, 2
    s_add_u32 s49, s49, 30720
    v_mov_b32 v250, s50
    v_mov_b32 v251, s49
    ds_write_b128 v5, a[64:67] offset:16384
    ds_write_b128 v5, a[68:71] offset:17408
    ds_write_b128 v5, a[72:75] offset:18432
    ds_write_b128 v5, a[76:79] offset:19456
    ds_write_b32 v251, v250
    v_mov_b32 v251, 30720
    s_waitcnt lgkmcnt(0)
    s_barrier
    ds_read_b128 v[252:255], v251
    ds_read_b64 v[240:241], v8 offset:0
    ds_read_b64 v[242:243], v8 offset:128
    ds_read_b64 v[244:245], v8 offset:256
    ds_read_b64 v[246:247], v8 offset:384
    ds_read_b64 v[248:249], v8 offset:512
    s_waitcnt lgkmcnt(5)
    v_or3_b32 v252, v252, v253, v254
    v_or_b32 v252, v252, v255
    s_nop 0
    v_readfirstlane_b32 s50, v252
    s_nop 3
    s_andn2_b32 s50, s50, s55
    s_cmp_lg_u32 s50, 0
    s_cbranch_scc1 L_fallback
    s_waitcnt lgkmcnt(0)
    ds_read_b128 v[16:19], v6 offset:0
    ds_read_b128 v[20:23], v6 offset:1024
    ds_read_b128 v[24:27], v6 offset:2048
    ds_read_b128 v[28:31], v6 offset:3072
    ds_read_b128 v[32:35], v6 offset:4096
    ds_read_b128 v[36:39], v6 offset:5120
    ds_read_b128 v[40:43], v6 offset:6144
    ds_read_b128 v[44:47], v6 offset:7168
    ds_read_b128 v[48:51], v6 offset:8192
    ds_read_b128 v[52:55], v6 offset:9216
    ds_read_b128 v[56:59], v6 offset:10240
    ds_read_b128 v[60:63], v6 offset:11264
    v_min_f32 v176, v200, v240
    v_min_f32 v178, v204, v242
    v_min_f32 v180, v208, v244
    v_min_f32 v182, v212, v246
    v_min_f32 v184, v216, v248
    v_sub_f32 v202, v176, v200
    v_sub_f32 v203, v176, v240
    v_sub_f32 v206, v178, v204
    v_sub_f32 v207, v178, v242
    v_sub_f32 v210, v180, v208
    v_sub_f32 v211, v180, v244
    v_sub_f32 v214, v182, v212
    v_sub_f32 v215, v182, v246
    v_sub_f32 v218, v184, v216
    v_sub_f32 v219, v184, v248
    v_exp_f32 v202, v202
    v_exp_f32 v203, v203
    v_exp_f32 v206, v206
    v_exp_f32 v207, v207
    v_exp_f32 v210, v210
    v_exp_f32 v211, v211
    v_exp_f32 v214, v214
    v_exp_f32 v215, v215
    v_exp_f32 v218, v218
    v_exp_f32 v219, v219
    v_mul_f32 v176, v202, v177
    v_mul_f32 v178, v206, v179
    v_mul_f32 v180, v210, v181
    v_mul_f32 v182, v214, v183
    v_mul_f32 v184, v218, v185
    v_fma_f32 v176, v203, v241, v176
    v_fma_f32 v178, v207, v243, v178
    v_fma_f32 v180, v211, v245, v180
    v_fma_f32 v182, v215, v247, v182
    v_fma_f32 v184, v219, v249, v184
    v_rcp_f32 v176, v176
    v_rcp_f32 v178, v178
    v_rcp_f32 v180, v180
    v_rcp_f32 v182, v182
    v_rcp_f32 v184, v184
    v_mul_f32 v200, v202, v176
    v_mul_f32 v201, v203, v176
    v_mul_f32 v204, v206, v178
    v_mul_f32 v205, v207, v178
    v_mul_f32 v208, v210, v180
    v_mul_f32 v209, v211, v180
    v_mul_f32 v212, v214, v182
    v_mul_f32 v213, v215, v182
    v_mul_f32 v216, v218, v184
    v_mul_f32 v217, v219, v184
    s_waitcnt lgkmcnt(8)
    ds_read_b128 v[64:67], v6 offset:12288
    ds_read_b128 v[68:71], v6 offset:13312
    ds_read_b128 v[72:75], v6 offset:14336
    ds_read_b128 v[76:79], v6 offset:15360
    v_pk_mul_f32 v[96:97], v[96:97], v[200:201] op_sel_hi:[1,0]
    v_pk_mul_f32 v[98:99], v[98:99], v[200:201] op_sel_hi:[1,0]
    v_pk_mul_f32 v[100:101], v[100:101], v[200:201] op_sel_hi:[1,0]
    v_pk_mul_f32 v[102:103], v[102:103], v[200:201] op_sel_hi:[1,0]
    v_pk_mul_f32 v[104:105], v[104:105], v[200:201] op_sel_hi:[1,0]
    v_pk_mul_f32 v[106:107], v[106:107], v[200:201] op_sel_hi:[1,0]
    v_pk_mul_f32 v[108:109], v[108:109], v[200:201] op_sel_hi:[1,0]
    v_pk_mul_f32 v[110:111], v[110:111], v[200:201] op_sel_hi:[1,0]
    v_pk_fma_f32 v[96:97], v[16:17], v[200:201], v[96:97] op_sel:[0,1,0]
    v_pk_fma_f32 v[98:99], v[18:19], v[200:201], v[98:99] op_sel:[0,1,0]
    v_pk_fma_f32 v[100:101], v[20:21], v[200:201], v[100:101] op_sel:[0,1,0]
    v_pk_fma_f32 v[102:103], v[22:23], v[200:201], v[102:103] op_sel:[0,1,0]
    v_pk_fma_f32 v[104:105], v[24:25], v[200:201], v[104:105] op_sel:[0,1,0]
    v_pk_fma_f32 v[106:107], v[26:27], v[200:201], v[106:107] op_sel:[0,1,0]
    v_pk_fma_f32 v[108:109], v[28:29], v[200:201], v[108:109] op_sel:[0,1,0]
    v_pk_fma_f32 v[110:111], v[30:31], v[200:201], v[110:111] op_sel:[0,1,0]
    v_cvt_pk_bf16_f32 v16, v96, v97
    v_cvt_pk_bf16_f32 v17, v98, v99
    v_cvt_pk_bf16_f32 v18, v100, v101
    v_cvt_pk_bf16_f32 v19, v102, v103
    v_cvt_pk_bf16_f32 v20, v104, v105
    v_cvt_pk_bf16_f32 v21, v106, v107
    v_cvt_pk_bf16_f32 v22, v108, v109
    v_cvt_pk_bf16_f32 v23, v110, v111
    ds_write_b64 v12, v[16:17] offset:0
    ds_write_b64 v13, v[18:19] offset:0
    ds_write_b64 v14, v[20:21] offset:0
    s_waitcnt lgkmcnt(11)
    ds_write_b64 v15, v[22:23] offset:0
    ds_read_b128 v[24:27], v9 offset:0
    ds_read_b128 v[28:31], v9 offset:1024
    v_pk_mul_f32 v[112:113], v[112:113], v[204:205] op_sel_hi:[1,0]
    v_pk_mul_f32 v[114:115], v[114:115], v[204:205] op_sel_hi:[1,0]
    v_pk_mul_f32 v[116:117], v[116:117], v[204:205] op_sel_hi:[1,0]
    v_pk_mul_f32 v[118:119], v[118:119], v[204:205] op_sel_hi:[1,0]
    v_pk_mul_f32 v[120:121], v[120:121], v[204:205] op_sel_hi:[1,0]
    v_pk_mul_f32 v[122:123], v[122:123], v[204:205] op_sel_hi:[1,0]
    v_pk_mul_f32 v[124:125], v[124:125], v[204:205] op_sel_hi:[1,0]
    v_pk_mul_f32 v[126:127], v[126:127], v[204:205] op_sel_hi:[1,0]
    ds_read_b128 v[80:83], v6 offset:16384
    s_waitcnt lgkmcnt(11)
    ds_read_b128 v[84:87], v6 offset:17408
    ds_read_b128 v[88:91], v6 offset:18432
    ds_read_b128 v[92:95], v6 offset:19456
    v_pk_fma_f32 v[112:113], v[32:33], v[204:205], v[112:113] op_sel:[0,1,0]
    v_pk_fma_f32 v[114:115], v[34:35], v[204:205], v[114:115] op_sel:[0,1,0]
    v_pk_fma_f32 v[116:117], v[36:37], v[204:205], v[116:117] op_sel:[0,1,0]
    v_pk_fma_f32 v[118:119], v[38:39], v[204:205], v[118:119] op_sel:[0,1,0]
    v_pk_fma_f32 v[120:121], v[40:41], v[204:205], v[120:121] op_sel:[0,1,0]
    v_pk_fma_f32 v[122:123], v[42:43], v[204:205], v[122:123] op_sel:[0,1,0]
    v_pk_fma_f32 v[124:125], v[44:45], v[204:205], v[124:125] op_sel:[0,1,0]
    v_pk_fma_f32 v[126:127], v[46:47], v[204:205], v[126:127] op_sel:[0,1,0]
    s_waitcnt lgkmcnt(4)
    buffer_store_dwordx4 v[24:27], v4, s[32:35], 0 offen nt
    buffer_store_dwordx4 v[28:31], v4, s[32:35], 0 offen offset:2048 nt
    v_cvt_pk_bf16_f32 v32, v112, v113
    v_cvt_pk_bf16_f32 v33, v114, v115
    v_cvt_pk_bf16_f32 v34, v116, v117
    v_cvt_pk_bf16_f32 v35, v118, v119
    v_cvt_pk_bf16_f32 v36, v120, v121
    v_cvt_pk_bf16_f32 v37, v122, v123
    v_cvt_pk_bf16_f32 v38, v124, v125
    v_cvt_pk_bf16_f32 v39, v126, v127
    ds_write_b64 v12, v[32:33] offset:2048
    ds_write_b64 v13, v[34:35] offset:2048
    ds_write_b64 v14, v[36:37] offset:2048
    ds_write_b64 v15, v[38:39] offset:2048
    ds_read_b128 v[40:43], v9 offset:2048
    ds_read_b128 v[44:47], v9 offset:3072
    v_pk_mul_f32 v[128:129], v[128:129], v[208:209] op_sel_hi:[1,0]
    v_pk_mul_f32 v[130:131], v[130:131], v[208:209] op_sel_hi:[1,0]
    v_pk_mul_f32 v[132:133], v[132:133], v[208:209] op_sel_hi:[1,0]
    v_pk_mul_f32 v[134:135], v[134:135], v[208:209] op_sel_hi:[1,0]
    v_pk_mul_f32 v[136:137], v[136:137], v[208:209] op_sel_hi:[1,0]
    v_pk_mul_f32 v[138:139], v[138:139], v[208:209] op_sel_hi:[1,0]
    v_pk_mul_f32 v[140:141], v[140:141], v[208:209] op_sel_hi:[1,0]
    v_pk_mul_f32 v[142:143], v[142:143], v[208:209] op_sel_hi:[1,0]
    v_pk_fma_f32 v[128:129], v[48:49], v[208:209], v[128:129] op_sel:[0,1,0]
    v_pk_fma_f32 v[130:131], v[50:51], v[208:209], v[130:131] op_sel:[0,1,0]
    v_pk_fma_f32 v[132:133], v[52:53], v[208:209], v[132:133] op_sel:[0,1,0]
    v_pk_fma_f32 v[134:135], v[54:55], v[208:209], v[134:135] op_sel:[0,1,0]
    v_pk_fma_f32 v[136:137], v[56:57], v[208:209], v[136:137] op_sel:[0,1,0]
    v_pk_fma_f32 v[138:139], v[58:59], v[208:209], v[138:139] op_sel:[0,1,0]
    v_pk_fma_f32 v[140:141], v[60:61], v[208:209], v[140:141] op_sel:[0,1,0]
    v_pk_fma_f32 v[142:143], v[62:63], v[208:209], v[142:143] op_sel:[0,1,0]
    s_waitcnt lgkmcnt(0)
    buffer_store_dwordx4 v[40:43], v4, s[32:35], s44 offen nt
    buffer_store_dwordx4 v[44:47], v4, s[32:35], s44 offen offset:2048 nt
    v_cvt_pk_bf16_f32 v48, v128, v129
    v_cvt_pk_bf16_f32 v49, v130, v131
    v_cvt_pk_bf16_f32 v50, v132, v133
    v_cvt_pk_bf16_f32 v51, v134, v135
    v_cvt_pk_bf16_f32 v52, v136, v137
    v_cvt_pk_bf16_f32 v53, v138, v139
    v_cvt_pk_bf16_f32 v54, v140, v141
    v_cvt_pk_bf16_f32 v55, v142, v143
    ds_write_b64 v12, v[48:49] offset:4096
    ds_write_b64 v13, v[50:51] offset:4096
    ds_write_b64 v14, v[52:53] offset:4096
    ds_write_b64 v15, v[54:55] offset:4096
    ds_read_b128 v[56:59], v9 offset:4096
    ds_read_b128 v[60:63], v9 offset:5120
    v_pk_mul_f32 v[144:145], v[144:145], v[212:213] op_sel_hi:[1,0]
    v_pk_mul_f32 v[146:147], v[146:147], v[212:213] op_sel_hi:[1,0]
    v_pk_mul_f32 v[148:149], v[148:149], v[212:213] op_sel_hi:[1,0]
    v_pk_mul_f32 v[150:151], v[150:151], v[212:213] op_sel_hi:[1,0]
    v_pk_mul_f32 v[152:153], v[152:153], v[212:213] op_sel_hi:[1,0]
    v_pk_mul_f32 v[154:155], v[154:155], v[212:213] op_sel_hi:[1,0]
    v_pk_mul_f32 v[156:157], v[156:157], v[212:213] op_sel_hi:[1,0]
    v_pk_mul_f32 v[158:159], v[158:159], v[212:213] op_sel_hi:[1,0]
    v_pk_fma_f32 v[144:145], v[64:65], v[212:213], v[144:145] op_sel:[0,1,0]
    v_pk_fma_f32 v[146:147], v[66:67], v[212:213], v[146:147] op_sel:[0,1,0]
    v_pk_fma_f32 v[148:149], v[68:69], v[212:213], v[148:149] op_sel:[0,1,0]
    v_pk_fma_f32 v[150:151], v[70:71], v[212:213], v[150:151] op_sel:[0,1,0]
    v_pk_fma_f32 v[152:153], v[72:73], v[212:213], v[152:153] op_sel:[0,1,0]
    v_pk_fma_f32 v[154:155], v[74:75], v[212:213], v[154:155] op_sel:[0,1,0]
    v_pk_fma_f32 v[156:157], v[76:77], v[212:213], v[156:157] op_sel:[0,1,0]
    v_pk_fma_f32 v[158:159], v[78:79], v[212:213], v[158:159] op_sel:[0,1,0]
    s_waitcnt lgkmcnt(0)
    buffer_store_dwordx4 v[56:59], v4, s[32:35], s45 offen nt
    buffer_store_dwordx4 v[60:63], v4, s[32:35], s45 offen offset:2048 nt
    v_cvt_pk_bf16_f32 v64, v144, v145
    v_cvt_pk_bf16_f32 v65, v146, v147
    v_cvt_pk_bf16_f32 v66, v148, v149
    v_cvt_pk_bf16_f32 v67, v150, v151
    v_cvt_pk_bf16_f32 v68, v152, v153
    v_cvt_pk_bf16_f32 v69, v154, v155
    v_cvt_pk_bf16_f32 v70, v156, v157
    v_cvt_pk_bf16_f32 v71, v158, v159
    ds_write_b64 v12, v[64:65] offset:6144
    ds_write_b64 v13, v[66:67] offset:6144
    ds_write_b64 v14, v[68:69] offset:6144
    ds_write_b64 v15, v[70:71] offset:6144
    ds_read_b128 v[72:75], v9 offset:6144
    ds_read_b128 v[76:79], v9 offset:7168
    v_pk_mul_f32 v[160:161], v[160:161], v[216:217] op_sel_hi:[1,0]
    v_pk_mul_f32 v[162:163], v[162:163], v[216:217] op_sel_hi:[1,0]
    v_pk_mul_f32 v[164:165], v[164:165], v[216:217] op_sel_hi:[1,0]
    v_pk_mul_f32 v[166:167], v[166:167], v[216:217] op_sel_hi:[1,0]
    v_pk_mul_f32 v[168:169], v[168:169], v[216:217] op_sel_hi:[1,0]
    v_pk_mul_f32 v[170:171], v[170:171], v[216:217] op_sel_hi:[1,0]
    v_pk_mul_f32 v[172:173], v[172:173], v[216:217] op_sel_hi:[1,0]
    v_pk_mul_f32 v[174:175], v[174:175], v[216:217] op_sel_hi:[1,0]
    v_pk_fma_f32 v[160:161], v[80:81], v[216:217], v[160:161] op_sel:[0,1,0]
    v_pk_fma_f32 v[162:163], v[82:83], v[216:217], v[162:163] op_sel:[0,1,0]
    v_pk_fma_f32 v[164:165], v[84:85], v[216:217], v[164:165] op_sel:[0,1,0]
    v_pk_fma_f32 v[166:167], v[86:87], v[216:217], v[166:167] op_sel:[0,1,0]
    v_pk_fma_f32 v[168:169], v[88:89], v[216:217], v[168:169] op_sel:[0,1,0]
    v_pk_fma_f32 v[170:171], v[90:91], v[216:217], v[170:171] op_sel:[0,1,0]
    v_pk_fma_f32 v[172:173], v[92:93], v[216:217], v[172:173] op_sel:[0,1,0]
    v_pk_fma_f32 v[174:175], v[94:95], v[216:217], v[174:175] op_sel:[0,1,0]
    s_waitcnt lgkmcnt(0)
    buffer_store_dwordx4 v[72:75], v4, s[32:35], s46 offen nt
    buffer_store_dwordx4 v[76:79], v4, s[32:35], s46 offen offset:2048 nt
    v_cvt_pk_bf16_f32 v80, v160, v161
    v_cvt_pk_bf16_f32 v81, v162, v163
    v_cvt_pk_bf16_f32 v82, v164, v165
    v_cvt_pk_bf16_f32 v83, v166, v167
    v_cvt_pk_bf16_f32 v84, v168, v169
    v_cvt_pk_bf16_f32 v85, v170, v171
    v_cvt_pk_bf16_f32 v86, v172, v173
    v_cvt_pk_bf16_f32 v87, v174, v175
    ds_write_b64 v12, v[80:81] offset:0
    ds_write_b64 v13, v[82:83] offset:0
    ds_write_b64 v14, v[84:85] offset:0
    ds_write_b64 v15, v[86:87] offset:0
    ds_read_b128 v[88:91], v9 offset:0
    ds_read_b128 v[92:95], v9 offset:1024
    s_waitcnt lgkmcnt(0)
    buffer_store_dwordx4 v[88:91], v4, s[32:35], s47 offen nt
    buffer_store_dwordx4 v[92:95], v4, s[32:35], s47 offen offset:2048 nt
    s_branch L_end
L_fallback:
    s_waitcnt lgkmcnt(0)
    s_mov_b32 s55, -1
    v_mov_b32 v240, 0xff800000
    v_mov_b32 v241, 0xff800000
    v_mov_b32 v242, 0xff800000
    v_mov_b32 v243, 0xff800000
    v_mov_b32 v244, 0xff800000
    v_and_b32 v232, 0x1fff, v232
    v_and_b32 v233, 0x1fff, v233
    v_and_b32 v234, 0x1fff, v234
    v_and_b32 v235, 0x1fff, v235
    s_mov_b32 s40, 0
L_fb_loop:
    s_waitcnt lgkmcnt(0)
    s_barrier
    s_add_u32 m0, s37, 0
    s_nop 0
    buffer_load_dwordx4 v232, s[12:15], 0 offen sc1 nt lds
    buffer_load_dwordx4 v233, s[12:15], 0 offen offset:1024 sc1 nt lds
    s_add_u32 m0, s37, 65536
    s_nop 0
    buffer_load_dwordx4 v232, s[16:19], 0 offen sc1 nt lds
    buffer_load_dwordx4 v233, s[16:19], 0 offen offset:1024 sc1 nt lds
    v_add_u32 v232, s45, v232
    v_add_u32 v233, s45, v233
    s_waitcnt vmcnt(0)
    s_barrier
    ds_read_b128 a[100:103], v220 offset:0
    ds_read_b128 a[104:107], v221 offset:0
    ds_read_b128 a[108:111], v222 offset:0
    ds_read_b128 a[112:115], v223 offset:0
    ds_read_b128 a[116:119], v220 offset:4096
    ds_read_b128 a[120:123], v221 offset:4096
    ds_read_b128 a[124:127], v222 offset:4096
    ds_read_b128 a[128:131], v223 offset:4096
    s_waitcnt lgkmcnt(0)
    v_mfma_f32_16x16x32_bf16 v[96:99], a[100:103], v[16:19], 0
    v_mfma_f32_16x16x32_bf16 v[96:99], a[104:107], v[20:23], v[96:99]
    v_mfma_f32_16x16x32_bf16 v[96:99], a[108:111], v[24:27], v[96:99]
    v_mfma_f32_16x16x32_bf16 v[96:99], a[112:115], v[28:31], v[96:99]
    v_mfma_f32_16x16x32_bf16 v[100:103], a[116:119], v[16:19], 0
    v_mfma_f32_16x16x32_bf16 v[100:103], a[120:123], v[20:23], v[100:103]
    v_mfma_f32_16x16x32_bf16 v[100:103], a[124:127], v[24:27], v[100:103]
    v_mfma_f32_16x16x32_bf16 v[100:103], a[128:131], v[28:31], v[100:103]
    v_mfma_f32_16x16x32_bf16 v[112:115], a[100:103], v[32:35], 0
    v_mfma_f32_16x16x32_bf16 v[112:115], a[104:107], v[36:39], v[112:115]
    v_mfma_f32_16x16x32_bf16 v[112:115], a[108:111], v[40:43], v[112:115]
    v_mfma_f32_16x16x32_bf16 v[112:115], a[112:115], v[44:47], v[112:115]
    v_mfma_f32_16x16x32_bf16 v[116:119], a[116:119], v[32:35], 0
    v_mfma_f32_16x16x32_bf16 v[116:119], a[120:123], v[36:39], v[116:119]
    v_mfma_f32_16x16x32_bf16 v[116:119], a[124:127], v[40:43], v[116:119]
    v_mfma_f32_16x16x32_bf16 v[116:119], a[128:131], v[44:47], v[116:119]
    v_mfma_f32_16x16x32_bf16 v[128:131], a[100:103], v[48:51], 0
    v_mfma_f32_16x16x32_bf16 v[128:131], a[104:107], v[52:55], v[128:131]
    v_mfma_f32_16x16x32_bf16 v[128:131], a[108:111], v[56:59], v[128:131]
    v_mfma_f32_16x16x32_bf16 v[128:131], a[112:115], v[60:63], v[128:131]
    v_mfma_f32_16x16x32_bf16 v[132:135], a[116:119], v[48:51], 0
    v_mfma_f32_16x16x32_bf16 v[132:135], a[120:123], v[52:55], v[132:135]
    v_mfma_f32_16x16x32_bf16 v[132:135], a[124:127], v[56:59], v[132:135]
    v_mfma_f32_16x16x32_bf16 v[132:135], a[128:131], v[60:63], v[132:135]
    v_mfma_f32_16x16x32_bf16 v[144:147], a[100:103], v[64:67], 0
    v_mfma_f32_16x16x32_bf16 v[144:147], a[104:107], v[68:71], v[144:147]
    v_mfma_f32_16x16x32_bf16 v[144:147], a[108:111], v[72:75], v[144:147]
    v_mfma_f32_16x16x32_bf16 v[144:147], a[112:115], v[76:79], v[144:147]
    v_mfma_f32_16x16x32_bf16 v[148:151], a[116:119], v[64:67], 0
    v_mfma_f32_16x16x32_bf16 v[148:151], a[120:123], v[68:71], v[148:151]
    v_mfma_f32_16x16x32_bf16 v[148:151], a[124:127], v[72:75], v[148:151]
    v_mfma_f32_16x16x32_bf16 v[148:151], a[128:131], v[76:79], v[148:151]
    v_mfma_f32_16x16x32_bf16 v[160:163], a[100:103], v[80:83], 0
    v_mfma_f32_16x16x32_bf16 v[160:163], a[104:107], v[84:87], v[160:163]
    v_mfma_f32_16x16x32_bf16 v[160:163], a[108:111], v[88:91], v[160:163]
    v_mfma_f32_16x16x32_bf16 v[160:163], a[112:115], v[92:95], v[160:163]
    v_mfma_f32_16x16x32_bf16 v[164:167], a[116:119], v[80:83], 0
    v_mfma_f32_16x16x32_bf16 v[164:167], a[120:123], v[84:87], v[164:167]
    v_mfma_f32_16x16x32_bf16 v[164:167], a[124:127], v[88:91], v[164:167]
    v_mfma_f32_16x16x32_bf16 v[164:167], a[128:131], v[92:95], v[164:167]
    s_nop 7
    s_nop 1
    v_max3_f32 v240, v240, v96, v97
    v_max3_f32 v240, v240, v98, v99
    v_max3_f32 v240, v240, v100, v101
    v_max3_f32 v240, v240, v102, v103
    v_max3_f32 v241, v241, v112, v113
    v_max3_f32 v241, v241, v114, v115
    v_max3_f32 v241, v241, v116, v117
    v_max3_f32 v241, v241, v118, v119
    v_max3_f32 v242, v242, v128, v129
    v_max3_f32 v242, v242, v130, v131
    v_max3_f32 v242, v242, v132, v133
    v_max3_f32 v242, v242, v134, v135
    v_max3_f32 v243, v243, v144, v145
    v_max3_f32 v243, v243, v146, v147
    v_max3_f32 v243, v243, v148, v149
    v_max3_f32 v243, v243, v150, v151
    v_max3_f32 v244, v244, v160, v161
    v_max3_f32 v244, v244, v162, v163
    v_max3_f32 v244, v244, v164, v165
    v_max3_f32 v244, v244, v166, v167
    s_add_u32 s40, s40, 1
    s_cmp_lt_u32 s40, 32
    s_cbranch_scc1 L_fb_loop
    v_and_b32 v232, 0x1fff, v232
    v_and_b32 v233, 0x1fff, v233
    s_barrier
    s_add_u32 m0, s37, 0
    s_nop 0
    buffer_load_dwordx4 v232, s[12:15], 0 offen sc1 nt lds
    buffer_load_dwordx4 v233, s[12:15], 0 offen offset:1024 sc1 nt lds
    s_add_u32 m0, s37, 65536
    s_nop 0
    buffer_load_dwordx4 v232, s[16:19], 0 offen sc1 nt lds
    buffer_load_dwordx4 v233, s[16:19], 0 offen offset:1024 sc1 nt lds
    v_add_u32 v232, s45, v232
    v_add_u32 v233, s45, v233
    s_add_u32 m0, s41, 0
    s_nop 0
    buffer_load_dwordx4 v234, s[20:23], 0 offen sc1 nt lds
    buffer_load_dwordx4 v235, s[20:23], 0 offen offset:1024 sc1 nt lds
    s_add_u32 m0, s41, 65536
    s_nop 0
    buffer_load_dwordx4 v234, s[24:27], 0 offen sc1 nt lds
    buffer_load_dwordx4 v235, s[24:27], 0 offen offset:1024 sc1 nt lds
    v_add_u32 v234, s45, v234
    v_add_u32 v235, s45, v235
    s_add_u32 m0, s37, 8192
    s_nop 0
    buffer_load_dwordx4 v232, s[12:15], 0 offen sc1 nt lds
    buffer_load_dwordx4 v233, s[12:15], 0 offen offset:1024 sc1 nt lds
    s_add_u32 m0, s37, 73728
    s_nop 0
    buffer_load_dwordx4 v232, s[16:19], 0 offen sc1 nt lds
    buffer_load_dwordx4 v233, s[16:19], 0 offen offset:1024 sc1 nt lds
    v_add_u32 v232, s45, v232
    v_add_u32 v233, s45, v233
    s_add_u32 m0, s41, 8192
    s_nop 0
    buffer_load_dwordx4 v234, s[20:23], 0 offen sc1 nt lds
    buffer_load_dwordx4 v235, s[20:23], 0 offen offset:1024 sc1 nt lds
    s_add_u32 m0, s41, 73728
    s_nop 0
    buffer_load_dwordx4 v234, s[24:27], 0 offen sc1 nt lds
    buffer_load_dwordx4 v235, s[24:27], 0 offen offset:1024 sc1 nt lds
    v_add_u32 v234, s45, v234
    v_add_u32 v235, s45, v235
    s_waitcnt vmcnt(8)
    s_barrier
    ds_read_b128 a[100:103], v220 offset:0
    ds_read_b128 a[104:107], v221 offset:0
    ds_read_b128 a[108:111], v222 offset:0
    ds_read_b128 a[112:115], v223 offset:0
    ds_read_b128 a[116:119], v220 offset:4096
    ds_read_b128 a[120:123], v221 offset:4096
    ds_read_b128 a[124:127], v222 offset:4096
    ds_read_b128 a[128:131], v223 offset:4096
    s_waitcnt lgkmcnt(4)
    ds_read_b64_tr_b16 a[164:165], v224 offset:0
    ds_read_b64_tr_b16 a[166:167], v224 offset:4096
    ds_read_b64_tr_b16 a[168:169], v225 offset:0
    ds_read_b64_tr_b16 a[170:171], v225 offset:4096
    ds_read_b64_tr_b16 a[172:173], v226 offset:0
    ds_read_b64_tr_b16 a[174:175], v226 offset:4096
    ds_read_b64_tr_b16 a[176:177], v227 offset:0
    ds_read_b64_tr_b16 a[178:179], v227 offset:4096
    s_waitcnt lgkmcnt(4)
    ds_read_b64_tr_b16 a[180:181], v228 offset:0
    ds_read_b64_tr_b16 a[182:183], v228 offset:4096
    ds_read_b64_tr_b16 a[184:185], v229 offset:0
    ds_read_b64_tr_b16 a[186:187], v229 offset:4096
    ds_read_b64_tr_b16 a[188:189], v230 offset:0
    ds_read_b64_tr_b16 a[190:191], v230 offset:4096
    ds_read_b64_tr_b16 a[192:193], v231 offset:0
    ds_read_b64_tr_b16 a[194:195], v231 offset:4096
    s_add_u32 m0, s37, 16384
    s_nop 0
    buffer_load_dwordx4 v232, s[12:15], 0 offen sc1 nt lds
    buffer_load_dwordx4 v233, s[12:15], 0 offen offset:1024 sc1 nt lds
    s_add_u32 m0, s37, 81920
    s_nop 0
    buffer_load_dwordx4 v232, s[16:19], 0 offen sc1 nt lds
    buffer_load_dwordx4 v233, s[16:19], 0 offen offset:1024 sc1 nt lds
    v_add_u32 v232, s45, v232
    v_add_u32 v233, s45, v233
    s_add_u32 m0, s41, 16384
    s_nop 0
    buffer_load_dwordx4 v234, s[20:23], 0 offen sc1 nt lds
    buffer_load_dwordx4 v235, s[20:23], 0 offen offset:1024 sc1 nt lds
    s_add_u32 m0, s41, 81920
    s_nop 0
    buffer_load_dwordx4 v234, s[24:27], 0 offen sc1 nt lds
    buffer_load_dwordx4 v235, s[24:27], 0 offen offset:1024 sc1 nt lds
    v_add_u32 v234, s45, v234
    v_add_u32 v235, s45, v235
    s_waitcnt lgkmcnt(0)
    v_mfma_f32_16x16x32_bf16 v[96:99], a[100:103], v[16:19], 0
    v_mfma_f32_16x16x32_bf16 v[96:99], a[104:107], v[20:23], v[96:99]
    v_mfma_f32_16x16x32_bf16 v[96:99], a[108:111], v[24:27], v[96:99]
    v_mfma_f32_16x16x32_bf16 v[96:99], a[112:115], v[28:31], v[96:99]
    v_mfma_f32_16x16x32_bf16 v[100:103], a[116:119], v[16:19], 0
    v_mfma_f32_16x16x32_bf16 v[100:103], a[120:123], v[20:23], v[100:103]
    v_mfma_f32_16x16x32_bf16 v[100:103], a[124:127], v[24:27], v[100:103]
    v_mfma_f32_16x16x32_bf16 v[100:103], a[128:131], v[28:31], v[100:103]
    s_nop 7
    s_nop 1
    v_max3_f32 v254, v96, v97, v98
    v_max3_f32 v254, v254, v99, v100
    v_max3_f32 v254, v254, v101, v102
    v_max3_f32 v254, v254, v103, v240
    v_mov_b32 v255, v254
    s_nop 1
    v_permlane32_swap_b32 v254, v255
    v_max_f32 v254, v254, v255
    v_mov_b32 v255, v254
    s_nop 1
    v_permlane16_swap_b32 v254, v255
    v_max_f32 v254, v254, v255
    v_sub_f32 v96, v96, v254
    v_sub_f32 v97, v97, v254
    v_sub_f32 v98, v98, v254
    v_sub_f32 v99, v99, v254
    v_sub_f32 v100, v100, v254
    v_sub_f32 v101, v101, v254
    v_sub_f32 v102, v102, v254
    v_sub_f32 v103, v103, v254
    v_sub_f32 v200, 0, v254
    v_sub_f32 v201, 0, v254
    v_sub_f32 v202, 0, v254
    v_sub_f32 v203, 0, v254
    v_exp_f32 v96, v96
    v_exp_f32 v97, v97
    v_exp_f32 v98, v98
    v_exp_f32 v99, v99
    v_exp_f32 v100, v100
    v_exp_f32 v101, v101
    v_exp_f32 v102, v102
    v_exp_f32 v103, v103
    v_cvt_pk_bf16_f32 v192, v96, v97
    v_cvt_pk_bf16_f32 v193, v98, v99
    v_cvt_pk_bf16_f32 v194, v100, v101
    v_cvt_pk_bf16_f32 v195, v102, v103
    s_nop 1
    v_mfma_f32_16x16x32_bf16 v[96:99], a[164:167], v[192:195], 0
    v_mfma_f32_16x16x32_bf16 v[100:103], a[168:171], v[192:195], 0
    v_mfma_f32_16x16x32_bf16 v[104:107], a[172:175], v[192:195], 0
    v_mfma_f32_16x16x32_bf16 v[108:111], a[176:179], v[192:195], 0
    v_mfma_f32_16x16x32_bf16 a[0:3], a[180:183], v[192:195], 0
    v_mfma_f32_16x16x32_bf16 a[4:7], a[184:187], v[192:195], 0
    v_mfma_f32_16x16x32_bf16 a[8:11], a[188:191], v[192:195], 0
    v_mfma_f32_16x16x32_bf16 a[12:15], a[192:195], v[192:195], 0
    v_mfma_f32_16x16x32_bf16 a[80:83], v[236:239], v[192:195], 0
    v_mfma_f32_16x16x32_bf16 v[112:115], a[100:103], v[32:35], 0
    v_mfma_f32_16x16x32_bf16 v[112:115], a[104:107], v[36:39], v[112:115]
    v_mfma_f32_16x16x32_bf16 v[112:115], a[108:111], v[40:43], v[112:115]
    v_mfma_f32_16x16x32_bf16 v[112:115], a[112:115], v[44:47], v[112:115]
    v_mfma_f32_16x16x32_bf16 v[116:119], a[116:119], v[32:35], 0
    v_mfma_f32_16x16x32_bf16 v[116:119], a[120:123], v[36:39], v[116:119]
    v_mfma_f32_16x16x32_bf16 v[116:119], a[124:127], v[40:43], v[116:119]
    v_mfma_f32_16x16x32_bf16 v[116:119], a[128:131], v[44:47], v[116:119]
    s_nop 7
    s_nop 1
    v_max3_f32 v254, v112, v113, v114
    v_max3_f32 v254, v254, v115, v116
    v_max3_f32 v254, v254, v117, v118
    v_max3_f32 v254, v254, v119, v241
    v_mov_b32 v255, v254
    s_nop 1
    v_permlane32_swap_b32 v254, v255
    v_max_f32 v254, v254, v255
    v_mov_b32 v255, v254
    s_nop 1
    v_permlane16_swap_b32 v254, v255
    v_max_f32 v254, v254, v255
    v_sub_f32 v112, v112, v254
    v_sub_f32 v113, v113, v254
    v_sub_f32 v114, v114, v254
    v_sub_f32 v115, v115, v254
    v_sub_f32 v116, v116, v254
    v_sub_f32 v117, v117, v254
    v_sub_f32 v118, v118, v254
    v_sub_f32 v119, v119, v254
    v_sub_f32 v204, 0, v254
    v_sub_f32 v205, 0, v254
    v_sub_f32 v206, 0, v254
    v_sub_f32 v207, 0, v254
    v_exp_f32 v112, v112
    v_exp_f32 v113, v113
    v_exp_f32 v114, v114
    v_exp_f32 v115, v115
    v_exp_f32 v116, v116
    v_exp_f32 v117, v117
    v_exp_f32 v118, v118
    v_exp_f32 v119, v119
    v_cvt_pk_bf16_f32 v196, v112, v113
    v_cvt_pk_bf16_f32 v197, v114, v115
    v_cvt_pk_bf16_f32 v198, v116, v117
    v_cvt_pk_bf16_f32 v199, v118, v119
    s_nop 1
    v_mfma_f32_16x16x32_bf16 v[112:115], a[164:167], v[196:199], 0
    v_mfma_f32_16x16x32_bf16 v[116:119], a[168:171], v[196:199], 0
    v_mfma_f32_16x16x32_bf16 v[120:123], a[172:175], v[196:199], 0
    v_mfma_f32_16x16x32_bf16 v[124:127], a[176:179], v[196:199], 0
    v_mfma_f32_16x16x32_bf16 a[16:19], a[180:183], v[196:199], 0
    v_mfma_f32_16x16x32_bf16 a[20:23], a[184:187], v[196:199], 0
    v_mfma_f32_16x16x32_bf16 a[24:27], a[188:191], v[196:199], 0
    v_mfma_f32_16x16x32_bf16 a[28:31], a[192:195], v[196:199], 0
    v_mfma_f32_16x16x32_bf16 a[84:87], v[236:239], v[196:199], 0
    v_mfma_f32_16x16x32_bf16 v[128:131], a[100:103], v[48:51], 0
    v_mfma_f32_16x16x32_bf16 v[128:131], a[104:107], v[52:55], v[128:131]
    v_mfma_f32_16x16x32_bf16 v[128:131], a[108:111], v[56:59], v[128:131]
    v_mfma_f32_16x16x32_bf16 v[128:131], a[112:115], v[60:63], v[128:131]
    v_mfma_f32_16x16x32_bf16 v[132:135], a[116:119], v[48:51], 0
    v_mfma_f32_16x16x32_bf16 v[132:135], a[120:123], v[52:55], v[132:135]
    v_mfma_f32_16x16x32_bf16 v[132:135], a[124:127], v[56:59], v[132:135]
    v_mfma_f32_16x16x32_bf16 v[132:135], a[128:131], v[60:63], v[132:135]
    s_nop 7
    s_nop 1
    v_max3_f32 v254, v128, v129, v130
    v_max3_f32 v254, v254, v131, v132
    v_max3_f32 v254, v254, v133, v134
    v_max3_f32 v254, v254, v135, v242
    v_mov_b32 v255, v254
    s_nop 1
    v_permlane32_swap_b32 v254, v255
    v_max_f32 v254, v254, v255
    v_mov_b32 v255, v254
    s_nop 1
    v_permlane16_swap_b32 v254, v255
    v_max_f32 v254, v254, v255
    v_sub_f32 v128, v128, v254
    v_sub_f32 v129, v129, v254
    v_sub_f32 v130, v130, v254
    v_sub_f32 v131, v131, v254
    v_sub_f32 v132, v132, v254
    v_sub_f32 v133, v133, v254
    v_sub_f32 v134, v134, v254
    v_sub_f32 v135, v135, v254
    v_sub_f32 v208, 0, v254
    v_sub_f32 v209, 0, v254
    v_sub_f32 v210, 0, v254
    v_sub_f32 v211, 0, v254
    v_exp_f32 v128, v128
    v_exp_f32 v129, v129
    v_exp_f32 v130, v130
    v_exp_f32 v131, v131
    v_exp_f32 v132, v132
    v_exp_f32 v133, v133
    v_exp_f32 v134, v134
    v_exp_f32 v135, v135
    v_cvt_pk_bf16_f32 v192, v128, v129
    v_cvt_pk_bf16_f32 v193, v130, v131
    v_cvt_pk_bf16_f32 v194, v132, v133
    v_cvt_pk_bf16_f32 v195, v134, v135
    s_nop 1
    v_mfma_f32_16x16x32_bf16 v[128:131], a[164:167], v[192:195], 0
    v_mfma_f32_16x16x32_bf16 v[132:135], a[168:171], v[192:195], 0
    v_mfma_f32_16x16x32_bf16 v[136:139], a[172:175], v[192:195], 0
    v_mfma_f32_16x16x32_bf16 v[140:143], a[176:179], v[192:195], 0
    v_mfma_f32_16x16x32_bf16 a[32:35], a[180:183], v[192:195], 0
    v_mfma_f32_16x16x32_bf16 a[36:39], a[184:187], v[192:195], 0
    v_mfma_f32_16x16x32_bf16 a[40:43], a[188:191], v[192:195], 0
    v_mfma_f32_16x16x32_bf16 a[44:47], a[192:195], v[192:195], 0
    v_mfma_f32_16x16x32_bf16 a[88:91], v[236:239], v[192:195], 0
    v_mfma_f32_16x16x32_bf16 v[144:147], a[100:103], v[64:67], 0
    v_mfma_f32_16x16x32_bf16 v[144:147], a[104:107], v[68:71], v[144:147]
    v_mfma_f32_16x16x32_bf16 v[144:147], a[108:111], v[72:75], v[144:147]
    v_mfma_f32_16x16x32_bf16 v[144:147], a[112:115], v[76:79], v[144:147]
    v_mfma_f32_16x16x32_bf16 v[148:151], a[116:119], v[64:67], 0
    v_mfma_f32_16x16x32_bf16 v[148:151], a[120:123], v[68:71], v[148:151]
    v_mfma_f32_16x16x32_bf16 v[148:151], a[124:127], v[72:75], v[148:151]
    v_mfma_f32_16x16x32_bf16 v[148:151], a[128:131], v[76:79], v[148:151]
    s_nop 7
    s_nop 1
    v_max3_f32 v254, v144, v145, v146
    v_max3_f32 v254, v254, v147, v148
    v_max3_f32 v254, v254, v149, v150
    v_max3_f32 v254, v254, v151, v243
    v_mov_b32 v255, v254
    s_nop 1
    v_permlane32_swap_b32 v254, v255
    v_max_f32 v254, v254, v255
    v_mov_b32 v255, v254
    s_nop 1
    v_permlane16_swap_b32 v254, v255
    v_max_f32 v254, v254, v255
    v_sub_f32 v144, v144, v254
    v_sub_f32 v145, v145, v254
    v_sub_f32 v146, v146, v254
    v_sub_f32 v147, v147, v254
    v_sub_f32 v148, v148, v254
    v_sub_f32 v149, v149, v254
    v_sub_f32 v150, v150, v254
    v_sub_f32 v151, v151, v254
    v_sub_f32 v212, 0, v254
    v_sub_f32 v213, 0, v254
    v_sub_f32 v214, 0, v254
    v_sub_f32 v215, 0, v254
    v_exp_f32 v144, v144
    v_exp_f32 v145, v145
    v_exp_f32 v146, v146
    v_exp_f32 v147, v147
    v_exp_f32 v148, v148
    v_exp_f32 v149, v149
    v_exp_f32 v150, v150
    v_exp_f32 v151, v151
    v_cvt_pk_bf16_f32 v196, v144, v145
    v_cvt_pk_bf16_f32 v197, v146, v147
    v_cvt_pk_bf16_f32 v198, v148, v149
    v_cvt_pk_bf16_f32 v199, v150, v151
    v_mfma_f32_16x16x32_bf16 v[160:163], a[100:103], v[80:83], 0
    v_mfma_f32_16x16x32_bf16 v[160:163], a[104:107], v[84:87], v[160:163]
    v_mfma_f32_16x16x32_bf16 v[160:163], a[108:111], v[88:91], v[160:163]
    v_mfma_f32_16x16x32_bf16 v[160:163], a[112:115], v[92:95], v[160:163]
    v_mfma_f32_16x16x32_bf16 v[164:167], a[116:119], v[80:83], 0
    v_mfma_f32_16x16x32_bf16 v[164:167], a[120:123], v[84:87], v[164:167]
    v_mfma_f32_16x16x32_bf16 v[164:167], a[124:127], v[88:91], v[164:167]
    v_mfma_f32_16x16x32_bf16 v[164:167], a[128:131], v[92:95], v[164:167]
    s_nop 7
    s_nop 1
    v_max3_f32 v254, v160, v161, v162
    v_max3_f32 v254, v254, v163, v164
    v_max3_f32 v254, v254, v165, v166
    v_max3_f32 v254, v254, v167, v244
    v_mov_b32 v255, v254
    s_nop 1
    v_permlane32_swap_b32 v254, v255
    v_max_f32 v254, v254, v255
    v_mov_b32 v255, v254
    s_nop 1
    v_permlane16_swap_b32 v254, v255
    v_max_f32 v254, v254, v255
    v_sub_f32 v160, v160, v254
    v_sub_f32 v161, v161, v254
    v_sub_f32 v162, v162, v254
    v_sub_f32 v163, v163, v254
    v_sub_f32 v164, v164, v254
    v_sub_f32 v165, v165, v254
    v_sub_f32 v166, v166, v254
    v_sub_f32 v167, v167, v254
    v_sub_f32 v216, 0, v254
    v_sub_f32 v217, 0, v254
    v_sub_f32 v218, 0, v254
    v_sub_f32 v219, 0, v254
    s_waitcnt vmcnt(8)
    s_barrier
    ds_read_b128 a[132:135], v220 offset:8192
    ds_read_b128 a[136:139], v221 offset:8192
    ds_read_b128 a[140:143], v222 offset:8192
    ds_read_b128 a[144:147], v223 offset:8192
    ds_read_b128 a[148:151], v220 offset:12288
    ds_read_b128 a[152:155], v221 offset:12288
    ds_read_b128 a[156:159], v222 offset:12288
    ds_read_b128 a[160:163], v223 offset:12288
    s_add_u32 m0, s37, 24576
    s_nop 0
    buffer_load_dwordx4 v232, s[12:15], 0 offen sc1 nt lds
    buffer_load_dwordx4 v233, s[12:15], 0 offen offset:1024 sc1 nt lds
    s_add_u32 m0, s37, 90112
    s_nop 0
    buffer_load_dwordx4 v232, s[16:19], 0 offen sc1 nt lds
    buffer_load_dwordx4 v233, s[16:19], 0 offen offset:1024 sc1 nt lds
    v_add_u32 v232, s45, v232
    v_add_u32 v233, s45, v233
    s_branch L_main
L_end:
    s_endpgm
.section .rodata,"a"
.p2align 6
.amdhsa_kernel standalone__gqa_softmax__near_ridge_kernel
  .amdhsa_next_free_vgpr 484
  .amdhsa_next_free_sgpr 64
  .amdhsa_accum_offset 256
  .amdhsa_group_segment_fixed_size 0
  .amdhsa_kernarg_size 48
  .amdhsa_user_sgpr_count 2
  .amdhsa_user_sgpr_kernarg_segment_ptr 1
  .amdhsa_system_sgpr_workgroup_id_x 1
  .amdhsa_float_denorm_mode_32 3
.end_amdhsa_kernel
```
